```python
import torch

def _softmax(x, axis=-1):
    return torch.softmax(x, dim=axis)
def _gelu(x):
    return torch.nn.functional.gelu(x, approximate="tanh")
def _silu(x):
    return torch.nn.functional.silu(x)
def _sigmoid(x):
    return torch.sigmoid(x)
def _layernorm(x, axis=-1, eps=1e-5):
    m = x.mean(dim=axis, keepdim=True)
    v = x.var(dim=axis, keepdim=True, unbiased=False)
    return (x - m) / torch.sqrt(v + eps)
def _scatter_add(tgt, idx, src, axis=0):
    return tgt.clone().index_add_(axis, idx, src)
def _segment_sum(src, seg, n):
    out = torch.zeros((n,) + src.shape[1:], dtype=src.dtype)
    return out.index_add_(0, seg, src)
def _pad(x, pw):
    flat = tuple(v for pair in reversed(pw) for v in pair)
    return torch.nn.functional.pad(x, flat)

kernel_name = 'recurrent_scan__mha_block_cached__geglu_ffn__decode'

def setup_inputs():

    _w = (lambda a: (lambda t: t.to(torch.bfloat16) if t.is_floating_point() else t)(torch.as_tensor(a)))
    def _A_setup():
        B, Sq, D = 8, 1, 512
        H, Sk, Dh = 32, 4096, 128
        return {
            "x": _w((lambda *s: torch.randn(*s, dtype=torch.bfloat16) * 0.05)(B, Sq, D)),
            "k_cache": _w((lambda *s: torch.randn(*s, dtype=torch.bfloat16) * 1.6)(B, H, Sk, Dh)),
            "v_cache": _w((lambda *s: torch.randn(*s, dtype=torch.bfloat16) * 0.2)(B, H, Sk, Dh)),
            "wq": _w((lambda *s: torch.randn(*s, dtype=torch.bfloat16) * 1.6)(D, H * Dh) * (D ** -0.5)),
            "wo": _w((lambda *s: torch.randn(*s, dtype=torch.bfloat16) * 0.2)(H * Dh, D) * ((H * Dh) ** -0.5)),
        }
    _A_in = _A_setup()

    def _B_setup():
        B, S, D, F = 8, 1, 512, 1792
        return {
            "x": _w((lambda *s: torch.randn(*s, dtype=torch.bfloat16) * 0.05)(B, S, D)),
            "w_gate": _w((lambda *s: torch.randn(*s, dtype=torch.bfloat16) * 0.1)(D, F)),
            "w_up": _w((lambda *s: torch.randn(*s, dtype=torch.bfloat16) * 0.1)(D, F)),
            "w_down": _w((lambda *s: torch.randn(*s, dtype=torch.bfloat16) * 0.1)(F, D)),
        }
    _B_in = _B_setup()

    return {
        "A_x": _A_in["x"],
        "A_k_cache": _A_in["k_cache"],
        "A_v_cache": _A_in["v_cache"],
        "A_wq": _A_in["wq"],
        "A_wo": _A_in["wo"],
        "B_x": _B_in["x"],
        "B_w_gate": _B_in["w_gate"],
        "B_w_up": _B_in["w_up"],
        "B_w_down": _B_in["w_down"],
    }

def reference(A_x, A_k_cache, A_v_cache, A_wq, A_wo, B_x, B_w_gate, B_w_up, B_w_down):
    def _A_ref(x, k_cache, v_cache, wq, wo):
        B, Sq, D = x.shape
        H, Dh = 32, 128
        q = (lambda x, *d: x.permute(*d))((x @ wq).reshape(B, Sq, H, Dh), 0, 2, 1, 3)
        scores = torch.einsum("bhqd,bhkd->bhqk", q, k_cache) * (Dh ** -0.5)
        p = _softmax(scores, axis=-1)
        o = torch.einsum("bhqk,bhkd->bhqd", p, v_cache)
        return (lambda x, *d: x.permute(*d))(o, 0, 2, 1, 3).reshape(B, Sq, H * Dh) @ wo

    def _B_ref(x, w_gate, w_up, w_down):
        return (_gelu(x @ w_gate) * (x @ w_up)) @ w_down

    x = A_x
    xn = _layernorm(x, axis=-1)
    s = _A_ref(xn, A_k_cache, A_v_cache, A_wq, A_wo)
    g = _silu(_B_ref(xn, B_w_gate, B_w_up, B_w_down))
    return x + s * g
```

```asm
; @launch grid=(256,1,1) block=(512,1,1) lds=104320
.amdgcn_target "amdgcn-amd-amdhsa--gfx950"
.text
.globl recurrent_scan__mha_block_cached__geglu_ffn__decode_kernel
.p2align 8
.type recurrent_scan__mha_block_cached__geglu_ffn__decode_kernel,@function
recurrent_scan__mha_block_cached__geglu_ffn__decode_kernel:
    s_cmp_ge_u32 s2, 256
    s_cbranch_scc1 L_end
    s_load_dwordx16 s[16:31], s[0:1], 0
    s_load_dwordx8 s[32:39], s[0:1], 64
    v_lshrrev_b32 v1, 6, v0
    v_and_b32 v0, 63, v0
    v_readfirstlane_b32 s3, v1
    v_and_b32 v4, 15, v0
    v_lshrrev_b32 v5, 4, v0
    s_lshr_b32 s4, s2, 5
    s_and_b32 s5, s2, 31
    s_and_b32 s94, s5, 7
    s_lshl_b32 s94, s94, 2
    s_lshr_b32 s6, s5, 3
    s_or_b32 s94, s94, s6
    s_mov_b32 s6, 1069066811
    s_mov_b32 s7, 0xffff0000
    s_mov_b32 s98, 0x400000
    s_mov_b32 s99, 0x20000
    s_cmp_ge_u32 s3, 4
    s_cbranch_scc1 L_helper
    s_setprio 3
    v_lshrrev_b32 v2, 2, v4
    v_lshlrev_b32 v2, 10, v2
    v_and_b32 v3, 3, v4
    v_lshl_add_u32 v2, v3, 6, v2
    v_lshl_add_u32 v2, v5, 4, v2
    v_lshlrev_b32 v3, 10, v5
    v_lshl_add_u32 v3, v4, 4, v3
    s_and_b32 s49, s3, 1
    s_lshl_b32 s49, s49, 13
    s_lshr_b32 s40, s3, 1
    s_lshl_b32 s40, s40, 15
    s_or_b32 s49, s49, s40
    s_mov_b32 s40, s49
    s_mov_b32 s50, 0
    s_lshl_b32 s41, s2, 20
    s_mov_b32 s10, 0x100000
    s_mov_b32 s11, 0x20000
    s_mov_b32 s14, 0x100000
    s_mov_b32 s15, 0x20000
    s_waitcnt lgkmcnt(0)
    s_add_u32 s8, s18, s41
    s_addc_u32 s9, s19, 0
    s_add_u32 s12, s20, s41
    s_addc_u32 s13, s21, 0
    s_mov_b32 s96, s38
    s_mov_b32 s97, s39
    buffer_load_dwordx4 v[96:99], v2, s[8:11], s40 offen offset:0 nt
    buffer_load_dwordx4 v[100:103], v2, s[8:11], s40 offen offset:256 nt
    buffer_load_dwordx4 v[104:107], v2, s[8:11], s40 offen offset:512 nt
    buffer_load_dwordx4 v[108:111], v2, s[8:11], s40 offen offset:768 nt
    s_add_u32 s50, s50, 1
    s_and_b32 s53, s50, 63
    s_and_b32 s41, s53, 1
    s_lshl_b32 s41, s41, 12
    s_xor_b32 s40, s49, s41
    s_and_b32 s41, s53, 2
    s_lshl_b32 s41, s41, 16
    s_xor_b32 s40, s40, s41
    s_and_b32 s41, s53, 4
    s_lshl_b32 s41, s41, 14
    s_xor_b32 s40, s40, s41
    s_and_b32 s41, s53, 24
    s_lshl_b32 s41, s41, 15
    s_xor_b32 s40, s40, s41
    s_and_b32 s41, s53, 16
    s_lshl_b32 s41, s41, 10
    s_xor_b32 s40, s40, s41
    s_and_b32 s41, s53, 32
    s_lshl_b32 s41, s41, 9
    s_xor_b32 s40, s40, s41
    buffer_load_dwordx4 v[112:115], v2, s[8:11], s40 offen offset:0 nt
    s_barrier
    v_and_b32 v6, 1, v4
    v_cmp_eq_u32 vcc, 1, v6
    v_mov_b32 v26, 0x0c0c0c0c
    v_mov_b32 v27, 202113280
    v_mov_b32 v7, 16780300
    v_cndmask_b32 v27, v27, v7, vcc
    v_mov_b32 v28, 202113794
    v_mov_b32 v7, 50465804
    v_cndmask_b32 v28, v28, v7, vcc
    v_lshrrev_b32 v7, 1, v4
    v_cmp_eq_u32 vcc, 0, v7
    s_nop 1
    v_cndmask_b32 v72, v26, v27, vcc
    v_cndmask_b32 v76, v26, v28, vcc
    v_cmp_eq_u32 vcc, 1, v7
    s_nop 1
    v_cndmask_b32 v73, v26, v27, vcc
    v_cndmask_b32 v77, v26, v28, vcc
    v_cmp_eq_u32 vcc, 2, v7
    s_nop 1
    v_cndmask_b32 v74, v26, v27, vcc
    v_cndmask_b32 v78, v26, v28, vcc
    v_cmp_eq_u32 vcc, 3, v7
    s_nop 1
    v_cndmask_b32 v75, v26, v27, vcc
    v_cndmask_b32 v79, v26, v28, vcc
    v_mov_b32 v64, 0
    v_mov_b32 v65, 0
    v_mov_b32 v66, 0
    v_mov_b32 v67, 0
    s_mov_b32 s42, 1035273459
    s_mov_b32 s54, 0x11111111
    s_mov_b32 s55, 0x11111111
    s_lshl_b32 s43, s3, 11
    s_add_u32 s43, s43, 96000
    v_lshl_add_u32 v26, v5, 3, s43
    v_lshl_add_u32 v27, v0, 5, s43
    v_mov_b32 v24, v26
    v_and_b32 v28, 3, v0
    v_lshlrev_b32 v28, 4, v28
    s_lshl_b32 s43, s3, 4
    v_mov_b32 v29, s43
    v_mov_b32 v70, 0
    v_mov_b32 v71, 1
    v_and_b32 v9, 3, v4
    v_lshlrev_b32 v15, 4, v5
    v_lshl_add_u32 v15, v9, 6, v15
    v_cmp_eq_u32 s[56:57], 1, v9
    v_cmp_eq_u32 s[58:59], 2, v9
    v_cmp_eq_u32 s[60:61], 3, v9
    v_lshlrev_b32 v68, 3, v5
    v_lshrrev_b32 v9, 2, v4
    v_lshl_add_u32 v68, v9, 1, v68
    s_lshl_b32 s43, s3, 11
    s_add_u32 s43, s43, 96000
    v_add_u32 v26, s43, v68
    v_and_b32 v8, 7, v0
    s_lshl_b32 s43, s4, 10
    s_lshl_b32 s45, s94, 5
    s_add_u32 s43, s43, s45
    v_lshl_add_u32 v9, v8, 1, s43
    v_lshrrev_b32 v25, 1, v8
    v_lshl_add_u32 v25, v25, 2, s43
    v_and_b32 v12, 1, v0
    v_lshl_add_u32 v25, v12, 4, v25
    s_lshl_b32 s43, s4, 16
    s_lshl_b32 s45, s94, 6
    s_add_u32 s43, s43, s45
    s_add_u32 s43, s43, 3145728
    v_lshrrev_b32 v12, 3, v0
    v_lshlrev_b32 v12, 11, v12
    v_lshl_add_u32 v12, v8, 3, v12
    v_add_u32 v12, s43, v12
    v_lshlrev_b32 v13, 2, v8
    v_and_b32 v14, 3, v0
    v_lshlrev_b32 v14, 1, v14
    v_lshlrev_b32 v6, 5, v4
    v_lshl_add_u32 v6, v5, 4, v6
    s_lshl_b32 s43, s3, 9
    v_add_u32 v6, s43, v6
    global_load_ushort v10, v9, s[16:17]
    global_load_ushort v11, v9, s[16:17] offset:16
    s_waitcnt vmcnt(4)
    buffer_load_dwordx4 v[116:119], v2, s[8:11], s40 offen offset:256 nt
    s_waitcnt vmcnt(4)
    buffer_load_dwordx4 v[120:123], v2, s[8:11], s40 offen offset:512 nt
    s_waitcnt vmcnt(4)
    buffer_load_dwordx4 v[124:127], v2, s[8:11], s40 offen offset:768 nt
    s_add_u32 s50, s50, 1
    s_and_b32 s53, s50, 63
    s_and_b32 s41, s53, 1
    s_lshl_b32 s41, s41, 12
    s_xor_b32 s40, s49, s41
    s_and_b32 s41, s53, 2
    s_lshl_b32 s41, s41, 16
    s_xor_b32 s40, s40, s41
    s_and_b32 s41, s53, 4
    s_lshl_b32 s41, s41, 14
    s_xor_b32 s40, s40, s41
    s_and_b32 s41, s53, 24
    s_lshl_b32 s41, s41, 15
    s_xor_b32 s40, s40, s41
    s_and_b32 s41, s53, 16
    s_lshl_b32 s41, s41, 10
    s_xor_b32 s40, s40, s41
    s_and_b32 s41, s53, 32
    s_lshl_b32 s41, s41, 9
    s_xor_b32 s40, s40, s41
    s_waitcnt vmcnt(4)
    buffer_load_dwordx4 v[128:131], v2, s[8:11], s40 offen offset:0 nt
    s_waitcnt vmcnt(4)
    buffer_load_dwordx4 v[132:135], v2, s[8:11], s40 offen offset:256 nt
    s_waitcnt vmcnt(4)
    buffer_load_dwordx4 v[136:139], v2, s[8:11], s40 offen offset:512 nt
    s_waitcnt vmcnt(4)
    buffer_load_dwordx4 v[140:143], v2, s[8:11], s40 offen offset:768 nt
    s_add_u32 s50, s50, 1
    s_and_b32 s53, s50, 63
    s_and_b32 s41, s53, 1
    s_lshl_b32 s41, s41, 12
    s_xor_b32 s40, s49, s41
    s_and_b32 s41, s53, 2
    s_lshl_b32 s41, s41, 16
    s_xor_b32 s40, s40, s41
    s_and_b32 s41, s53, 4
    s_lshl_b32 s41, s41, 14
    s_xor_b32 s40, s40, s41
    s_and_b32 s41, s53, 24
    s_lshl_b32 s41, s41, 15
    s_xor_b32 s40, s40, s41
    s_and_b32 s41, s53, 16
    s_lshl_b32 s41, s41, 10
    s_xor_b32 s40, s40, s41
    s_and_b32 s41, s53, 32
    s_lshl_b32 s41, s41, 9
    s_xor_b32 s40, s40, s41
    s_waitcnt vmcnt(4)
    buffer_load_dwordx4 v[144:147], v2, s[8:11], s40 offen offset:0 nt
    s_waitcnt vmcnt(4)
    buffer_load_dwordx4 v[148:151], v2, s[8:11], s40 offen offset:256 nt
    s_waitcnt vmcnt(4)
    buffer_load_dwordx4 v[152:155], v2, s[8:11], s40 offen offset:512 nt
    s_waitcnt vmcnt(4)
    buffer_load_dwordx4 v[156:159], v2, s[8:11], s40 offen offset:768 nt
    s_add_u32 s50, s50, 1
    s_and_b32 s53, s50, 63
    s_and_b32 s41, s53, 1
    s_lshl_b32 s41, s41, 12
    s_xor_b32 s40, s49, s41
    s_and_b32 s41, s53, 2
    s_lshl_b32 s41, s41, 16
    s_xor_b32 s40, s40, s41
    s_and_b32 s41, s53, 4
    s_lshl_b32 s41, s41, 14
    s_xor_b32 s40, s40, s41
    s_and_b32 s41, s53, 24
    s_lshl_b32 s41, s41, 15
    s_xor_b32 s40, s40, s41
    s_and_b32 s41, s53, 16
    s_lshl_b32 s41, s41, 10
    s_xor_b32 s40, s40, s41
    s_and_b32 s41, s53, 32
    s_lshl_b32 s41, s41, 9
    s_xor_b32 s40, s40, s41
    s_waitcnt vmcnt(4)
    buffer_load_dwordx4 v[160:163], v2, s[8:11], s40 offen offset:0 nt
    s_waitcnt vmcnt(4)
    buffer_load_dwordx4 v[164:167], v2, s[8:11], s40 offen offset:256 nt
    s_waitcnt vmcnt(4)
    buffer_load_dwordx4 v[168:171], v2, s[8:11], s40 offen offset:512 nt
    s_waitcnt vmcnt(4)
    buffer_load_dwordx4 v[172:175], v2, s[8:11], s40 offen offset:768 nt
    s_add_u32 s50, s50, 1
    s_and_b32 s53, s50, 63
    s_and_b32 s41, s53, 1
    s_lshl_b32 s41, s41, 12
    s_xor_b32 s40, s49, s41
    s_and_b32 s41, s53, 2
    s_lshl_b32 s41, s41, 16
    s_xor_b32 s40, s40, s41
    s_and_b32 s41, s53, 4
    s_lshl_b32 s41, s41, 14
    s_xor_b32 s40, s40, s41
    s_and_b32 s41, s53, 24
    s_lshl_b32 s41, s41, 15
    s_xor_b32 s40, s40, s41
    s_and_b32 s41, s53, 16
    s_lshl_b32 s41, s41, 10
    s_xor_b32 s40, s40, s41
    s_and_b32 s41, s53, 32
    s_lshl_b32 s41, s41, 9
    s_xor_b32 s40, s40, s41
    s_waitcnt vmcnt(4)
    buffer_load_dwordx4 v[176:179], v2, s[8:11], s40 offen offset:0 nt
    s_waitcnt vmcnt(4)
    buffer_load_dwordx4 v[180:183], v2, s[8:11], s40 offen offset:256 nt
    s_waitcnt vmcnt(4)
    buffer_load_dwordx4 v[184:187], v2, s[8:11], s40 offen offset:512 nt
    s_waitcnt vmcnt(4)
    buffer_load_dwordx4 v[188:191], v2, s[8:11], s40 offen offset:768 nt
    s_add_u32 s50, s50, 1
    s_and_b32 s53, s50, 63
    s_and_b32 s41, s53, 1
    s_lshl_b32 s41, s41, 12
    s_xor_b32 s40, s49, s41
    s_and_b32 s41, s53, 2
    s_lshl_b32 s41, s41, 16
    s_xor_b32 s40, s40, s41
    s_and_b32 s41, s53, 4
    s_lshl_b32 s41, s41, 14
    s_xor_b32 s40, s40, s41
    s_and_b32 s41, s53, 24
    s_lshl_b32 s41, s41, 15
    s_xor_b32 s40, s40, s41
    s_and_b32 s41, s53, 16
    s_lshl_b32 s41, s41, 10
    s_xor_b32 s40, s40, s41
    s_and_b32 s41, s53, 32
    s_lshl_b32 s41, s41, 9
    s_xor_b32 s40, s40, s41
    s_waitcnt vmcnt(4)
    buffer_load_dwordx4 v[192:195], v2, s[8:11], s40 offen offset:0 nt
    s_waitcnt vmcnt(4)
    buffer_load_dwordx4 v[196:199], v2, s[8:11], s40 offen offset:256 nt
    s_waitcnt vmcnt(4)
    buffer_load_dwordx4 v[200:203], v2, s[8:11], s40 offen offset:512 nt
    s_waitcnt vmcnt(4)
    buffer_load_dwordx4 v[204:207], v2, s[8:11], s40 offen offset:768 nt
    s_add_u32 s50, s50, 1
    s_and_b32 s53, s50, 63
    s_and_b32 s41, s53, 1
    s_lshl_b32 s41, s41, 12
    s_xor_b32 s40, s49, s41
    s_and_b32 s41, s53, 2
    s_lshl_b32 s41, s41, 16
    s_xor_b32 s40, s40, s41
    s_and_b32 s41, s53, 4
    s_lshl_b32 s41, s41, 14
    s_xor_b32 s40, s40, s41
    s_and_b32 s41, s53, 24
    s_lshl_b32 s41, s41, 15
    s_xor_b32 s40, s40, s41
    s_and_b32 s41, s53, 16
    s_lshl_b32 s41, s41, 10
    s_xor_b32 s40, s40, s41
    s_and_b32 s41, s53, 32
    s_lshl_b32 s41, s41, 9
    s_xor_b32 s40, s40, s41
    s_waitcnt vmcnt(4)
    buffer_load_dwordx4 v[208:211], v2, s[8:11], s40 offen offset:0 nt
    s_waitcnt vmcnt(4)
    buffer_load_dwordx4 v[212:215], v2, s[8:11], s40 offen offset:256 nt
    s_waitcnt vmcnt(4)
    buffer_load_dwordx4 v[216:219], v2, s[8:11], s40 offen offset:512 nt
    s_waitcnt vmcnt(4)
    buffer_load_dwordx4 v[220:223], v2, s[8:11], s40 offen offset:768 nt
    s_add_u32 s50, s50, 1
    s_and_b32 s53, s50, 63
    s_and_b32 s41, s53, 1
    s_lshl_b32 s41, s41, 12
    s_xor_b32 s40, s49, s41
    s_and_b32 s41, s53, 2
    s_lshl_b32 s41, s41, 16
    s_xor_b32 s40, s40, s41
    s_and_b32 s41, s53, 4
    s_lshl_b32 s41, s41, 14
    s_xor_b32 s40, s40, s41
    s_and_b32 s41, s53, 24
    s_lshl_b32 s41, s41, 15
    s_xor_b32 s40, s40, s41
    s_and_b32 s41, s53, 16
    s_lshl_b32 s41, s41, 10
    s_xor_b32 s40, s40, s41
    s_and_b32 s41, s53, 32
    s_lshl_b32 s41, s41, 9
    s_xor_b32 s40, s40, s41
    s_barrier
    ds_read_b128 v[40:43], v15 offset:0
    s_waitcnt vmcnt(4)
    buffer_load_dwordx4 v[224:227], v2, s[8:11], s40 offen offset:0 nt
    v_lshrrev_b32 v44, 2, v4
    s_waitcnt lgkmcnt(0)
    v_cmp_eq_u32 vcc, 0, v44
    s_nop 1
    v_cndmask_b32 v16, 0, v40, vcc
    v_cndmask_b32 v17, 0, v41, vcc
    v_cndmask_b32 v18, 0, v42, vcc
    v_cndmask_b32 v19, 0, v43, vcc
    v_cmp_eq_u32 vcc, 1, v44
    s_nop 1
    v_cndmask_b32 v20, 0, v40, vcc
    v_cndmask_b32 v21, 0, v41, vcc
    v_cndmask_b32 v22, 0, v42, vcc
    v_cndmask_b32 v23, 0, v43, vcc
    v_cmp_eq_u32 vcc, 2, v44
    s_nop 1
    v_cndmask_b32 v32, 0, v40, vcc
    v_cndmask_b32 v33, 0, v41, vcc
    v_cndmask_b32 v34, 0, v42, vcc
    v_cndmask_b32 v35, 0, v43, vcc
    v_cmp_eq_u32 vcc, 3, v44
    s_nop 1
    v_cndmask_b32 v60, 0, v40, vcc
    v_cndmask_b32 v61, 0, v41, vcc
    v_cndmask_b32 v62, 0, v42, vcc
    v_cndmask_b32 v63, 0, v43, vcc
    v_mfma_f32_16x16x32_bf16 v[36:39], v[96:99], v[16:19], 0
    v_mfma_f32_16x16x32_bf16 v[36:39], v[100:103], v[20:23], v[36:39]
    v_mfma_f32_16x16x32_bf16 v[36:39], v[104:107], v[32:35], v[36:39]
    v_mfma_f32_16x16x32_bf16 v[36:39], v[108:111], v[60:63], v[36:39]
    s_waitcnt vmcnt(4)
    buffer_load_dwordx4 v[228:231], v2, s[8:11], s40 offen offset:256 nt
    s_nop 5
    v_cndmask_b32 v40, v36, v37, s[56:57]
    v_cndmask_b32 v40, v40, v38, s[58:59]
    v_cndmask_b32 v40, v40, v39, s[60:61]
    s_nop 1
    v_add_f32_dpp v40, v40, v40 quad_perm:[1,0,3,2] row_mask:0xf bank_mask:0xf
    s_nop 1
    v_add_f32_dpp v40, v40, v40 quad_perm:[2,3,0,1] row_mask:0xf bank_mask:0xf
    s_waitcnt vmcnt(4)
    buffer_load_dwordx4 v[232:235], v2, s[8:11], s40 offen offset:512 nt
    v_cvt_pk_bf16_f32 v40, v40, v40
    v_and_b32 v40, s7, v40
    v_mul_f32 v40, s42, v40
    v_cvt_pk_bf16_f32 v48, v40, v40
    s_mov_b64 exec, s[54:55]
    ds_write_b16 v26, v48 offset:0
    s_mov_b64 exec, -1
    v_mfma_f32_16x16x32_bf16 v[36:39], v[112:115], v[16:19], 0
    v_mfma_f32_16x16x32_bf16 v[36:39], v[116:119], v[20:23], v[36:39]
    v_mfma_f32_16x16x32_bf16 v[36:39], v[120:123], v[32:35], v[36:39]
    v_mfma_f32_16x16x32_bf16 v[36:39], v[124:127], v[60:63], v[36:39]
    s_waitcnt vmcnt(4)
    buffer_load_dwordx4 v[236:239], v2, s[8:11], s40 offen offset:768 nt
    s_add_u32 s50, s50, 1
    s_and_b32 s53, s50, 63
    s_and_b32 s41, s53, 1
    s_lshl_b32 s41, s41, 12
    s_xor_b32 s40, s49, s41
    s_and_b32 s41, s53, 2
    s_lshl_b32 s41, s41, 16
    s_xor_b32 s40, s40, s41
    s_and_b32 s41, s53, 4
    s_lshl_b32 s41, s41, 14
    s_xor_b32 s40, s40, s41
    s_and_b32 s41, s53, 24
    s_lshl_b32 s41, s41, 15
    s_xor_b32 s40, s40, s41
    s_and_b32 s41, s53, 16
    s_lshl_b32 s41, s41, 10
    s_xor_b32 s40, s40, s41
    s_and_b32 s41, s53, 32
    s_lshl_b32 s41, s41, 9
    s_xor_b32 s40, s40, s41
    v_cndmask_b32 v40, v36, v37, s[56:57]
    v_cndmask_b32 v40, v40, v38, s[58:59]
    v_cndmask_b32 v40, v40, v39, s[60:61]
    s_nop 1
    v_add_f32_dpp v40, v40, v40 quad_perm:[1,0,3,2] row_mask:0xf bank_mask:0xf
    s_nop 1
    v_add_f32_dpp v40, v40, v40 quad_perm:[2,3,0,1] row_mask:0xf bank_mask:0xf
    s_waitcnt vmcnt(4)
    buffer_load_dwordx4 v[240:243], v2, s[8:11], s40 offen offset:0 nt
    v_cvt_pk_bf16_f32 v40, v40, v40
    v_and_b32 v40, s7, v40
    v_mul_f32 v40, s42, v40
    v_cvt_pk_bf16_f32 v49, v40, v40
    s_mov_b64 exec, s[54:55]
    ds_write_b16 v26, v49 offset:32
    s_mov_b64 exec, -1
    v_add_u32 v26, 64, v26
    v_mfma_f32_16x16x32_bf16 v[36:39], v[128:131], v[16:19], 0
    v_mfma_f32_16x16x32_bf16 v[36:39], v[132:135], v[20:23], v[36:39]
    v_mfma_f32_16x16x32_bf16 v[36:39], v[136:139], v[32:35], v[36:39]
    v_mfma_f32_16x16x32_bf16 v[36:39], v[140:143], v[60:63], v[36:39]
    s_waitcnt vmcnt(4)
    buffer_load_dwordx4 v[244:247], v2, s[8:11], s40 offen offset:256 nt
    s_nop 5
    v_cndmask_b32 v40, v36, v37, s[56:57]
    v_cndmask_b32 v40, v40, v38, s[58:59]
    v_cndmask_b32 v40, v40, v39, s[60:61]
    s_nop 1
    v_add_f32_dpp v40, v40, v40 quad_perm:[1,0,3,2] row_mask:0xf bank_mask:0xf
    s_nop 1
    v_add_f32_dpp v40, v40, v40 quad_perm:[2,3,0,1] row_mask:0xf bank_mask:0xf
    s_waitcnt vmcnt(4)
    buffer_load_dwordx4 v[248:251], v2, s[8:11], s40 offen offset:512 nt
    v_cvt_pk_bf16_f32 v40, v40, v40
    v_and_b32 v40, s7, v40
    v_mul_f32 v40, s42, v40
    v_cvt_pk_bf16_f32 v48, v40, v40
    s_mov_b64 exec, s[54:55]
    ds_write_b16 v26, v48 offset:0
    s_mov_b64 exec, -1
    v_mfma_f32_16x16x32_bf16 v[36:39], v[144:147], v[16:19], 0
    v_mfma_f32_16x16x32_bf16 v[36:39], v[148:151], v[20:23], v[36:39]
    v_mfma_f32_16x16x32_bf16 v[36:39], v[152:155], v[32:35], v[36:39]
    v_mfma_f32_16x16x32_bf16 v[36:39], v[156:159], v[60:63], v[36:39]
    s_waitcnt vmcnt(4)
    buffer_load_dwordx4 v[252:255], v2, s[8:11], s40 offen offset:768 nt
    s_add_u32 s50, s50, 1
    s_and_b32 s53, s50, 63
    s_and_b32 s41, s53, 1
    s_lshl_b32 s41, s41, 12
    s_xor_b32 s40, s49, s41
    s_and_b32 s41, s53, 2
    s_lshl_b32 s41, s41, 16
    s_xor_b32 s40, s40, s41
    s_and_b32 s41, s53, 4
    s_lshl_b32 s41, s41, 14
    s_xor_b32 s40, s40, s41
    s_and_b32 s41, s53, 24
    s_lshl_b32 s41, s41, 15
    s_xor_b32 s40, s40, s41
    s_and_b32 s41, s53, 16
    s_lshl_b32 s41, s41, 10
    s_xor_b32 s40, s40, s41
    s_and_b32 s41, s53, 32
    s_lshl_b32 s41, s41, 9
    s_xor_b32 s40, s40, s41
    v_cndmask_b32 v40, v36, v37, s[56:57]
    v_cndmask_b32 v40, v40, v38, s[58:59]
    v_cndmask_b32 v40, v40, v39, s[60:61]
    s_nop 1
    v_add_f32_dpp v40, v40, v40 quad_perm:[1,0,3,2] row_mask:0xf bank_mask:0xf
    s_nop 1
    v_add_f32_dpp v40, v40, v40 quad_perm:[2,3,0,1] row_mask:0xf bank_mask:0xf
    v_cvt_pk_bf16_f32 v40, v40, v40
    v_and_b32 v40, s7, v40
    v_mul_f32 v40, s42, v40
    v_cvt_pk_bf16_f32 v49, v40, v40
    s_mov_b64 exec, s[54:55]
    ds_write_b16 v26, v49 offset:32
    s_mov_b64 exec, -1
    v_add_u32 v26, 64, v26
    v_mfma_f32_16x16x32_bf16 v[36:39], v[160:163], v[16:19], 0
    v_mfma_f32_16x16x32_bf16 v[36:39], v[164:167], v[20:23], v[36:39]
    v_mfma_f32_16x16x32_bf16 v[36:39], v[168:171], v[32:35], v[36:39]
    v_mfma_f32_16x16x32_bf16 v[36:39], v[172:175], v[60:63], v[36:39]
    s_waitcnt vmcnt(4)
    buffer_load_dwordx4 v[96:99], v2, s[8:11], s40 offen offset:0 nt
    s_nop 5
    v_cndmask_b32 v40, v36, v37, s[56:57]
    v_cndmask_b32 v40, v40, v38, s[58:59]
    v_cndmask_b32 v40, v40, v39, s[60:61]
    s_nop 1
    v_add_f32_dpp v40, v40, v40 quad_perm:[1,0,3,2] row_mask:0xf bank_mask:0xf
    s_nop 1
    v_add_f32_dpp v40, v40, v40 quad_perm:[2,3,0,1] row_mask:0xf bank_mask:0xf
    s_waitcnt vmcnt(4)
    buffer_load_dwordx4 v[100:103], v2, s[8:11], s40 offen offset:256 nt
    v_cvt_pk_bf16_f32 v40, v40, v40
    v_and_b32 v40, s7, v40
    v_mul_f32 v40, s42, v40
    v_cvt_pk_bf16_f32 v48, v40, v40
    s_mov_b64 exec, s[54:55]
    ds_write_b16 v26, v48 offset:0
    s_mov_b64 exec, -1
    v_mfma_f32_16x16x32_bf16 v[36:39], v[176:179], v[16:19], 0
    v_mfma_f32_16x16x32_bf16 v[36:39], v[180:183], v[20:23], v[36:39]
    v_mfma_f32_16x16x32_bf16 v[36:39], v[184:187], v[32:35], v[36:39]
    v_mfma_f32_16x16x32_bf16 v[36:39], v[188:191], v[60:63], v[36:39]
    s_waitcnt vmcnt(4)
    buffer_load_dwordx4 v[104:107], v2, s[8:11], s40 offen offset:512 nt
    s_nop 5
    v_cndmask_b32 v40, v36, v37, s[56:57]
    v_cndmask_b32 v40, v40, v38, s[58:59]
    v_cndmask_b32 v40, v40, v39, s[60:61]
    s_nop 1
    v_add_f32_dpp v40, v40, v40 quad_perm:[1,0,3,2] row_mask:0xf bank_mask:0xf
    s_nop 1
    v_add_f32_dpp v40, v40, v40 quad_perm:[2,3,0,1] row_mask:0xf bank_mask:0xf
    v_cvt_pk_bf16_f32 v40, v40, v40
    v_and_b32 v40, s7, v40
    v_mul_f32 v40, s42, v40
    v_cvt_pk_bf16_f32 v49, v40, v40
    s_mov_b64 exec, s[54:55]
    ds_write_b16 v26, v49 offset:32
    s_mov_b64 exec, -1
    v_add_u32 v26, 64, v26
    v_mfma_f32_16x16x32_bf16 v[36:39], v[192:195], v[16:19], 0
    v_mfma_f32_16x16x32_bf16 v[36:39], v[196:199], v[20:23], v[36:39]
    v_mfma_f32_16x16x32_bf16 v[36:39], v[200:203], v[32:35], v[36:39]
    v_mfma_f32_16x16x32_bf16 v[36:39], v[204:207], v[60:63], v[36:39]
    s_waitcnt vmcnt(4)
    buffer_load_dwordx4 v[108:111], v2, s[8:11], s40 offen offset:768 nt
    s_add_u32 s50, s50, 1
    s_and_b32 s53, s50, 63
    s_and_b32 s41, s53, 1
    s_lshl_b32 s41, s41, 12
    s_xor_b32 s40, s49, s41
    s_and_b32 s41, s53, 2
    s_lshl_b32 s41, s41, 16
    s_xor_b32 s40, s40, s41
    s_and_b32 s41, s53, 4
    s_lshl_b32 s41, s41, 14
    s_xor_b32 s40, s40, s41
    s_and_b32 s41, s53, 24
    s_lshl_b32 s41, s41, 15
    s_xor_b32 s40, s40, s41
    s_and_b32 s41, s53, 16
    s_lshl_b32 s41, s41, 10
    s_xor_b32 s40, s40, s41
    s_and_b32 s41, s53, 32
    s_lshl_b32 s41, s41, 9
    s_xor_b32 s40, s40, s41
    v_cndmask_b32 v40, v36, v37, s[56:57]
    v_cndmask_b32 v40, v40, v38, s[58:59]
    v_cndmask_b32 v40, v40, v39, s[60:61]
    s_nop 1
    v_add_f32_dpp v40, v40, v40 quad_perm:[1,0,3,2] row_mask:0xf bank_mask:0xf
    s_nop 1
    v_add_f32_dpp v40, v40, v40 quad_perm:[2,3,0,1] row_mask:0xf bank_mask:0xf
    s_waitcnt vmcnt(4)
    buffer_load_dwordx4 v[112:115], v2, s[8:11], s40 offen offset:0 nt
    v_cvt_pk_bf16_f32 v40, v40, v40
    v_and_b32 v40, s7, v40
    v_mul_f32 v40, s42, v40
    v_cvt_pk_bf16_f32 v48, v40, v40
    s_mov_b64 exec, s[54:55]
    ds_write_b16 v26, v48 offset:0
    s_mov_b64 exec, -1
    v_mfma_f32_16x16x32_bf16 v[36:39], v[208:211], v[16:19], 0
    v_mfma_f32_16x16x32_bf16 v[36:39], v[212:215], v[20:23], v[36:39]
    v_mfma_f32_16x16x32_bf16 v[36:39], v[216:219], v[32:35], v[36:39]
    v_mfma_f32_16x16x32_bf16 v[36:39], v[220:223], v[60:63], v[36:39]
    s_waitcnt vmcnt(4)
    buffer_load_dwordx4 v[116:119], v2, s[8:11], s40 offen offset:256 nt
    s_nop 5
    v_cndmask_b32 v40, v36, v37, s[56:57]
    v_cndmask_b32 v40, v40, v38, s[58:59]
    v_cndmask_b32 v40, v40, v39, s[60:61]
    s_nop 1
    v_add_f32_dpp v40, v40, v40 quad_perm:[1,0,3,2] row_mask:0xf bank_mask:0xf
    s_nop 1
    v_add_f32_dpp v40, v40, v40 quad_perm:[2,3,0,1] row_mask:0xf bank_mask:0xf
    v_cvt_pk_bf16_f32 v40, v40, v40
    v_and_b32 v40, s7, v40
    v_mul_f32 v40, s42, v40
    v_cvt_pk_bf16_f32 v49, v40, v40
    s_mov_b64 exec, s[54:55]
    ds_write_b16 v26, v49 offset:32
    s_mov_b64 exec, -1
    v_add_u32 v26, 64, v26
    v_mfma_f32_16x16x32_bf16 v[36:39], v[224:227], v[16:19], 0
    v_mfma_f32_16x16x32_bf16 v[36:39], v[228:231], v[20:23], v[36:39]
    v_mfma_f32_16x16x32_bf16 v[36:39], v[232:235], v[32:35], v[36:39]
    v_mfma_f32_16x16x32_bf16 v[36:39], v[236:239], v[60:63], v[36:39]
    s_waitcnt vmcnt(4)
    buffer_load_dwordx4 v[120:123], v2, s[8:11], s40 offen offset:512 nt
    s_nop 5
    v_cndmask_b32 v40, v36, v37, s[56:57]
    v_cndmask_b32 v40, v40, v38, s[58:59]
    v_cndmask_b32 v40, v40, v39, s[60:61]
    s_nop 1
    v_add_f32_dpp v40, v40, v40 quad_perm:[1,0,3,2] row_mask:0xf bank_mask:0xf
    s_nop 1
    v_add_f32_dpp v40, v40, v40 quad_perm:[2,3,0,1] row_mask:0xf bank_mask:0xf
    s_waitcnt vmcnt(4)
    buffer_load_dwordx4 v[124:127], v2, s[8:11], s40 offen offset:768 nt
    s_add_u32 s50, s50, 1
    s_and_b32 s53, s50, 63
    s_and_b32 s41, s53, 1
    s_lshl_b32 s41, s41, 12
    s_xor_b32 s40, s49, s41
    s_and_b32 s41, s53, 2
    s_lshl_b32 s41, s41, 16
    s_xor_b32 s40, s40, s41
    s_and_b32 s41, s53, 4
    s_lshl_b32 s41, s41, 14
    s_xor_b32 s40, s40, s41
    s_and_b32 s41, s53, 24
    s_lshl_b32 s41, s41, 15
    s_xor_b32 s40, s40, s41
    s_and_b32 s41, s53, 16
    s_lshl_b32 s41, s41, 10
    s_xor_b32 s40, s40, s41
    s_and_b32 s41, s53, 32
    s_lshl_b32 s41, s41, 9
    s_xor_b32 s40, s40, s41
    v_cvt_pk_bf16_f32 v40, v40, v40
    v_and_b32 v40, s7, v40
    v_mul_f32 v40, s42, v40
    v_cvt_pk_bf16_f32 v48, v40, v40
    s_mov_b64 exec, s[54:55]
    ds_write_b16 v26, v48 offset:0
    s_mov_b64 exec, -1
    v_mfma_f32_16x16x32_bf16 v[36:39], v[240:243], v[16:19], 0
    v_mfma_f32_16x16x32_bf16 v[36:39], v[244:247], v[20:23], v[36:39]
    v_mfma_f32_16x16x32_bf16 v[36:39], v[248:251], v[32:35], v[36:39]
    v_mfma_f32_16x16x32_bf16 v[36:39], v[252:255], v[60:63], v[36:39]
    s_waitcnt vmcnt(4)
    buffer_load_dwordx4 v[128:131], v2, s[8:11], s40 offen offset:0 nt
    s_nop 5
    v_cndmask_b32 v40, v36, v37, s[56:57]
    v_cndmask_b32 v40, v40, v38, s[58:59]
    v_cndmask_b32 v40, v40, v39, s[60:61]
    s_nop 1
    v_add_f32_dpp v40, v40, v40 quad_perm:[1,0,3,2] row_mask:0xf bank_mask:0xf
    s_nop 1
    v_add_f32_dpp v40, v40, v40 quad_perm:[2,3,0,1] row_mask:0xf bank_mask:0xf
    v_cvt_pk_bf16_f32 v40, v40, v40
    v_and_b32 v40, s7, v40
    v_mul_f32 v40, s42, v40
    v_cvt_pk_bf16_f32 v49, v40, v40
    s_mov_b64 exec, s[54:55]
    ds_write_b16 v26, v49 offset:32
    s_mov_b64 exec, -1
    v_add_u32 v26, 64, v26
    s_waitcnt vmcnt(4)
    buffer_load_dwordx4 v[132:135], v2, s[8:11], s40 offen offset:256 nt
    s_waitcnt vmcnt(4)
    buffer_load_dwordx4 v[136:139], v2, s[8:11], s40 offen offset:512 nt
    s_waitcnt vmcnt(4)
    buffer_load_dwordx4 v[140:143], v2, s[8:11], s40 offen offset:768 nt
    s_add_u32 s50, s50, 1
    s_and_b32 s53, s50, 63
    s_and_b32 s41, s53, 1
    s_lshl_b32 s41, s41, 12
    s_xor_b32 s40, s49, s41
    s_and_b32 s41, s53, 2
    s_lshl_b32 s41, s41, 16
    s_xor_b32 s40, s40, s41
    s_and_b32 s41, s53, 4
    s_lshl_b32 s41, s41, 14
    s_xor_b32 s40, s40, s41
    s_and_b32 s41, s53, 24
    s_lshl_b32 s41, s41, 15
    s_xor_b32 s40, s40, s41
    s_and_b32 s41, s53, 16
    s_lshl_b32 s41, s41, 10
    s_xor_b32 s40, s40, s41
    s_and_b32 s41, s53, 32
    s_lshl_b32 s41, s41, 9
    s_xor_b32 s40, s40, s41
    s_waitcnt vmcnt(4)
    buffer_load_dwordx4 v[144:147], v2, s[8:11], s40 offen offset:0 nt
    s_waitcnt vmcnt(4)
    buffer_load_dwordx4 v[148:151], v2, s[8:11], s40 offen offset:256 nt
    s_waitcnt vmcnt(4)
    buffer_load_dwordx4 v[152:155], v2, s[8:11], s40 offen offset:512 nt
    s_waitcnt vmcnt(4)
    buffer_load_dwordx4 v[156:159], v2, s[8:11], s40 offen offset:768 nt
    s_add_u32 s50, s50, 1
    s_and_b32 s53, s50, 63
    s_and_b32 s41, s53, 1
    s_lshl_b32 s41, s41, 12
    s_xor_b32 s40, s49, s41
    s_and_b32 s41, s53, 2
    s_lshl_b32 s41, s41, 16
    s_xor_b32 s40, s40, s41
    s_and_b32 s41, s53, 4
    s_lshl_b32 s41, s41, 14
    s_xor_b32 s40, s40, s41
    s_and_b32 s41, s53, 24
    s_lshl_b32 s41, s41, 15
    s_xor_b32 s40, s40, s41
    s_and_b32 s41, s53, 16
    s_lshl_b32 s41, s41, 10
    s_xor_b32 s40, s40, s41
    s_and_b32 s41, s53, 32
    s_lshl_b32 s41, s41, 9
    s_xor_b32 s40, s40, s41
    s_mov_b32 s44, 12
    ds_read_b32 v31, v70 offset:2500
    v_mov_b32 v30, -3
    s_mov_b32 s51, -4
    s_waitcnt lgkmcnt(0)
    v_readfirstlane_b32 s43, v31
    v_readfirstlane_b32 s45, v30
    s_nop 0
    s_sub_i32 s45, s45, s51
    s_add_u32 s51, s51, 8
    s_cmp_ge_i32 s45, 3
    s_addc_u32 s43, s43, 0
    s_cmp_le_i32 s45, 0
    s_subb_u32 s43, s43, 0
    s_cmp_eq_u32 s43, 0
    s_cbranch_scc1 L_k0
    s_cmp_eq_u32 s43, 1
    s_cbranch_scc1 L_k1
    s_cmp_eq_u32 s43, 2
    s_cbranch_scc1 L_k2
    s_cmp_eq_u32 s43, 3
    s_cbranch_scc1 L_k3
    s_cmp_eq_u32 s43, 4
    s_cbranch_scc1 L_k4
    s_cmp_eq_u32 s43, 5
    s_cbranch_scc1 L_k5
    s_branch L_k6
L_k0:
    s_mov_b64 exec, 1
    ds_add_u32 v70, v71 offset:2496
    s_mov_b64 exec, -1
    v_mfma_f32_16x16x32_bf16 v[36:39], v[96:99], v[16:19], 0
    v_mfma_f32_16x16x32_bf16 v[36:39], v[100:103], v[20:23], v[36:39]
    v_mfma_f32_16x16x32_bf16 v[36:39], v[104:107], v[32:35], v[36:39]
    v_mfma_f32_16x16x32_bf16 v[36:39], v[108:111], v[60:63], v[36:39]
    s_waitcnt vmcnt(3)
    buffer_load_dwordx4 v[96:99], v2, s[8:11], s40 offen offset:0 nt
    s_nop 5
    v_cndmask_b32 v40, v36, v37, s[56:57]
    v_cndmask_b32 v40, v40, v38, s[58:59]
    s_waitcnt vmcnt(3)
    buffer_load_dwordx4 v[100:103], v2, s[8:11], s40 offen offset:256 nt
    v_cndmask_b32 v40, v40, v39, s[60:61]
    s_nop 1
    v_add_f32_dpp v40, v40, v40 quad_perm:[1,0,3,2] row_mask:0xf bank_mask:0xf
    s_nop 1
    v_add_f32_dpp v40, v40, v40 quad_perm:[2,3,0,1] row_mask:0xf bank_mask:0xf
    s_waitcnt vmcnt(3)
    buffer_load_dwordx4 v[104:107], v2, s[8:11], s40 offen offset:512 nt
    v_cvt_pk_bf16_f32 v40, v40, v40
    v_and_b32 v40, s7, v40
    s_waitcnt vmcnt(3)
    buffer_load_dwordx4 v[108:111], v2, s[8:11], s40 offen offset:768 nt
    s_add_u32 s50, s50, 1
    s_and_b32 s53, s50, 63
    s_and_b32 s41, s53, 1
    s_lshl_b32 s41, s41, 12
    s_xor_b32 s40, s49, s41
    s_and_b32 s41, s53, 2
    s_lshl_b32 s41, s41, 16
    s_xor_b32 s40, s40, s41
    s_and_b32 s41, s53, 4
    s_lshl_b32 s41, s41, 14
    s_xor_b32 s40, s40, s41
    s_and_b32 s41, s53, 24
    s_lshl_b32 s41, s41, 15
    s_xor_b32 s40, s40, s41
    s_and_b32 s41, s53, 16
    s_lshl_b32 s41, s41, 10
    s_xor_b32 s40, s40, s41
    s_and_b32 s41, s53, 32
    s_lshl_b32 s41, s41, 9
    s_xor_b32 s40, s40, s41
    v_mul_f32 v40, s42, v40
    v_cvt_pk_bf16_f32 v48, v40, v40
    s_mov_b64 exec, s[54:55]
    ds_write_b16 v26, v48 offset:0
    s_mov_b64 exec, -1
    v_mfma_f32_16x16x32_bf16 v[36:39], v[112:115], v[16:19], 0
    v_mfma_f32_16x16x32_bf16 v[36:39], v[116:119], v[20:23], v[36:39]
    v_mfma_f32_16x16x32_bf16 v[36:39], v[120:123], v[32:35], v[36:39]
    v_mfma_f32_16x16x32_bf16 v[36:39], v[124:127], v[60:63], v[36:39]
    s_waitcnt vmcnt(3)
    buffer_load_dwordx4 v[112:115], v2, s[8:11], s40 offen offset:0 nt
    s_nop 5
    v_cndmask_b32 v40, v36, v37, s[56:57]
    v_cndmask_b32 v40, v40, v38, s[58:59]
    s_waitcnt vmcnt(3)
    buffer_load_dwordx4 v[116:119], v2, s[8:11], s40 offen offset:256 nt
    v_cndmask_b32 v40, v40, v39, s[60:61]
    s_nop 1
    v_add_f32_dpp v40, v40, v40 quad_perm:[1,0,3,2] row_mask:0xf bank_mask:0xf
    s_nop 1
    v_add_f32_dpp v40, v40, v40 quad_perm:[2,3,0,1] row_mask:0xf bank_mask:0xf
    s_waitcnt vmcnt(3)
    buffer_load_dwordx4 v[120:123], v2, s[8:11], s40 offen offset:512 nt
    v_cvt_pk_bf16_f32 v40, v40, v40
    v_and_b32 v40, s7, v40
    s_waitcnt vmcnt(3)
    buffer_load_dwordx4 v[124:127], v2, s[8:11], s40 offen offset:768 nt
    s_add_u32 s50, s50, 1
    s_and_b32 s53, s50, 63
    s_and_b32 s41, s53, 1
    s_lshl_b32 s41, s41, 12
    s_xor_b32 s40, s49, s41
    s_and_b32 s41, s53, 2
    s_lshl_b32 s41, s41, 16
    s_xor_b32 s40, s40, s41
    s_and_b32 s41, s53, 4
    s_lshl_b32 s41, s41, 14
    s_xor_b32 s40, s40, s41
    s_and_b32 s41, s53, 24
    s_lshl_b32 s41, s41, 15
    s_xor_b32 s40, s40, s41
    s_and_b32 s41, s53, 16
    s_lshl_b32 s41, s41, 10
    s_xor_b32 s40, s40, s41
    s_and_b32 s41, s53, 32
    s_lshl_b32 s41, s41, 9
    s_xor_b32 s40, s40, s41
    v_mul_f32 v40, s42, v40
    v_cvt_pk_bf16_f32 v49, v40, v40
    s_mov_b64 exec, s[54:55]
    ds_write_b16 v26, v49 offset:32
    s_mov_b64 exec, -1
    v_add_u32 v26, 64, v26
    s_mov_b64 exec, 1
    ds_add_rtn_u32 v30, v70, v71 offset:2496
    s_mov_b64 exec, -1
    ds_read_b32 v31, v70 offset:2500
    v_mfma_f32_16x16x32_bf16 v[36:39], v[128:131], v[16:19], 0
    v_mfma_f32_16x16x32_bf16 v[36:39], v[132:135], v[20:23], v[36:39]
    v_mfma_f32_16x16x32_bf16 v[36:39], v[136:139], v[32:35], v[36:39]
    v_mfma_f32_16x16x32_bf16 v[36:39], v[140:143], v[60:63], v[36:39]
    s_waitcnt vmcnt(3)
    buffer_load_dwordx4 v[128:131], v2, s[8:11], s40 offen offset:0 nt
    s_nop 5
    v_cndmask_b32 v40, v36, v37, s[56:57]
    v_cndmask_b32 v40, v40, v38, s[58:59]
    s_waitcnt vmcnt(3)
    buffer_load_dwordx4 v[132:135], v2, s[8:11], s40 offen offset:256 nt
    v_cndmask_b32 v40, v40, v39, s[60:61]
    s_nop 1
    v_add_f32_dpp v40, v40, v40 quad_perm:[1,0,3,2] row_mask:0xf bank_mask:0xf
    s_nop 1
    v_add_f32_dpp v40, v40, v40 quad_perm:[2,3,0,1] row_mask:0xf bank_mask:0xf
    s_waitcnt vmcnt(3)
    buffer_load_dwordx4 v[136:139], v2, s[8:11], s40 offen offset:512 nt
    v_cvt_pk_bf16_f32 v40, v40, v40
    v_and_b32 v40, s7, v40
    s_waitcnt vmcnt(3)
    buffer_load_dwordx4 v[140:143], v2, s[8:11], s40 offen offset:768 nt
    s_add_u32 s50, s50, 1
    s_and_b32 s53, s50, 63
    s_and_b32 s41, s53, 1
    s_lshl_b32 s41, s41, 12
    s_xor_b32 s40, s49, s41
    s_and_b32 s41, s53, 2
    s_lshl_b32 s41, s41, 16
    s_xor_b32 s40, s40, s41
    s_and_b32 s41, s53, 4
    s_lshl_b32 s41, s41, 14
    s_xor_b32 s40, s40, s41
    s_and_b32 s41, s53, 24
    s_lshl_b32 s41, s41, 15
    s_xor_b32 s40, s40, s41
    s_and_b32 s41, s53, 16
    s_lshl_b32 s41, s41, 10
    s_xor_b32 s40, s40, s41
    s_and_b32 s41, s53, 32
    s_lshl_b32 s41, s41, 9
    s_xor_b32 s40, s40, s41
    v_mul_f32 v40, s42, v40
    v_cvt_pk_bf16_f32 v48, v40, v40
    s_mov_b64 exec, s[54:55]
    ds_write_b16 v26, v48 offset:0
    s_mov_b64 exec, -1
    v_mfma_f32_16x16x32_bf16 v[36:39], v[144:147], v[16:19], 0
    v_mfma_f32_16x16x32_bf16 v[36:39], v[148:151], v[20:23], v[36:39]
    v_mfma_f32_16x16x32_bf16 v[36:39], v[152:155], v[32:35], v[36:39]
    v_mfma_f32_16x16x32_bf16 v[36:39], v[156:159], v[60:63], v[36:39]
    s_waitcnt vmcnt(3)
    buffer_load_dwordx4 v[144:147], v2, s[8:11], s40 offen offset:0 nt
    s_nop 5
    v_cndmask_b32 v40, v36, v37, s[56:57]
    v_cndmask_b32 v40, v40, v38, s[58:59]
    s_waitcnt vmcnt(3)
    buffer_load_dwordx4 v[148:151], v2, s[8:11], s40 offen offset:256 nt
    v_cndmask_b32 v40, v40, v39, s[60:61]
    s_nop 1
    v_add_f32_dpp v40, v40, v40 quad_perm:[1,0,3,2] row_mask:0xf bank_mask:0xf
    s_nop 1
    v_add_f32_dpp v40, v40, v40 quad_perm:[2,3,0,1] row_mask:0xf bank_mask:0xf
    s_waitcnt vmcnt(3)
    buffer_load_dwordx4 v[152:155], v2, s[8:11], s40 offen offset:512 nt
    v_cvt_pk_bf16_f32 v40, v40, v40
    v_and_b32 v40, s7, v40
    s_waitcnt vmcnt(3)
    buffer_load_dwordx4 v[156:159], v2, s[8:11], s40 offen offset:768 nt
    s_add_u32 s50, s50, 1
    s_and_b32 s53, s50, 63
    s_and_b32 s41, s53, 1
    s_lshl_b32 s41, s41, 12
    s_xor_b32 s40, s49, s41
    s_and_b32 s41, s53, 2
    s_lshl_b32 s41, s41, 16
    s_xor_b32 s40, s40, s41
    s_and_b32 s41, s53, 4
    s_lshl_b32 s41, s41, 14
    s_xor_b32 s40, s40, s41
    s_and_b32 s41, s53, 24
    s_lshl_b32 s41, s41, 15
    s_xor_b32 s40, s40, s41
    s_and_b32 s41, s53, 16
    s_lshl_b32 s41, s41, 10
    s_xor_b32 s40, s40, s41
    s_and_b32 s41, s53, 32
    s_lshl_b32 s41, s41, 9
    s_xor_b32 s40, s40, s41
    v_mul_f32 v40, s42, v40
    v_cvt_pk_bf16_f32 v49, v40, v40
    s_mov_b64 exec, s[54:55]
    ds_write_b16 v26, v49 offset:32
    s_mov_b64 exec, -1
    v_add_u32 v26, 64, v26
    s_sub_u32 s44, s44, 1
    s_cmp_eq_u32 s44, 0
    s_cbranch_scc1 L_k_end
    s_waitcnt lgkmcnt(2)
    v_readfirstlane_b32 s43, v31
    v_readfirstlane_b32 s45, v30
    s_nop 0
    s_sub_i32 s45, s45, s51
    s_add_u32 s51, s51, 8
    s_cmp_ge_i32 s45, 3
    s_addc_u32 s43, s43, 0
    s_cmp_le_i32 s45, 0
    s_subb_u32 s43, s43, 0
    s_cmp_eq_u32 s43, 0
    s_cbranch_scc1 L_k0
    s_cmp_eq_u32 s43, 1
    s_cbranch_scc1 L_k1
    s_cmp_eq_u32 s43, 2
    s_cbranch_scc1 L_k2
    s_cmp_eq_u32 s43, 3
    s_cbranch_scc1 L_k3
    s_cmp_eq_u32 s43, 4
    s_cbranch_scc1 L_k4
    s_cmp_eq_u32 s43, 5
    s_cbranch_scc1 L_k5
    s_branch L_k6
L_k1:
    s_mov_b64 exec, 1
    ds_add_u32 v70, v71 offset:2496
    s_mov_b64 exec, -1
    v_mfma_f32_16x16x32_bf16 v[36:39], v[96:99], v[16:19], 0
    v_mfma_f32_16x16x32_bf16 v[36:39], v[100:103], v[20:23], v[36:39]
    v_mfma_f32_16x16x32_bf16 v[36:39], v[104:107], v[32:35], v[36:39]
    v_mfma_f32_16x16x32_bf16 v[36:39], v[108:111], v[60:63], v[36:39]
    s_waitcnt vmcnt(4)
    buffer_load_dwordx4 v[96:99], v2, s[8:11], s40 offen offset:0 nt
    s_nop 5
    v_cndmask_b32 v40, v36, v37, s[56:57]
    v_cndmask_b32 v40, v40, v38, s[58:59]
    s_waitcnt vmcnt(4)
    buffer_load_dwordx4 v[100:103], v2, s[8:11], s40 offen offset:256 nt
    v_cndmask_b32 v40, v40, v39, s[60:61]
    s_nop 1
    v_add_f32_dpp v40, v40, v40 quad_perm:[1,0,3,2] row_mask:0xf bank_mask:0xf
    s_nop 1
    v_add_f32_dpp v40, v40, v40 quad_perm:[2,3,0,1] row_mask:0xf bank_mask:0xf
    s_waitcnt vmcnt(4)
    buffer_load_dwordx4 v[104:107], v2, s[8:11], s40 offen offset:512 nt
    v_cvt_pk_bf16_f32 v40, v40, v40
    v_and_b32 v40, s7, v40
    s_waitcnt vmcnt(4)
    buffer_load_dwordx4 v[108:111], v2, s[8:11], s40 offen offset:768 nt
    s_add_u32 s50, s50, 1
    s_and_b32 s53, s50, 63
    s_and_b32 s41, s53, 1
    s_lshl_b32 s41, s41, 12
    s_xor_b32 s40, s49, s41
    s_and_b32 s41, s53, 2
    s_lshl_b32 s41, s41, 16
    s_xor_b32 s40, s40, s41
    s_and_b32 s41, s53, 4
    s_lshl_b32 s41, s41, 14
    s_xor_b32 s40, s40, s41
    s_and_b32 s41, s53, 24
    s_lshl_b32 s41, s41, 15
    s_xor_b32 s40, s40, s41
    s_and_b32 s41, s53, 16
    s_lshl_b32 s41, s41, 10
    s_xor_b32 s40, s40, s41
    s_and_b32 s41, s53, 32
    s_lshl_b32 s41, s41, 9
    s_xor_b32 s40, s40, s41
    v_mul_f32 v40, s42, v40
    v_cvt_pk_bf16_f32 v48, v40, v40
    s_mov_b64 exec, s[54:55]
    ds_write_b16 v26, v48 offset:0
    s_mov_b64 exec, -1
    v_mfma_f32_16x16x32_bf16 v[36:39], v[112:115], v[16:19], 0
    v_mfma_f32_16x16x32_bf16 v[36:39], v[116:119], v[20:23], v[36:39]
    v_mfma_f32_16x16x32_bf16 v[36:39], v[120:123], v[32:35], v[36:39]
    v_mfma_f32_16x16x32_bf16 v[36:39], v[124:127], v[60:63], v[36:39]
    s_waitcnt vmcnt(3)
    buffer_load_dwordx4 v[112:115], v2, s[8:11], s40 offen offset:0 nt
    s_nop 5
    v_cndmask_b32 v40, v36, v37, s[56:57]
    v_cndmask_b32 v40, v40, v38, s[58:59]
    s_waitcnt vmcnt(3)
    buffer_load_dwordx4 v[116:119], v2, s[8:11], s40 offen offset:256 nt
    v_cndmask_b32 v40, v40, v39, s[60:61]
    s_nop 1
    v_add_f32_dpp v40, v40, v40 quad_perm:[1,0,3,2] row_mask:0xf bank_mask:0xf
    s_nop 1
    v_add_f32_dpp v40, v40, v40 quad_perm:[2,3,0,1] row_mask:0xf bank_mask:0xf
    s_waitcnt vmcnt(3)
    buffer_load_dwordx4 v[120:123], v2, s[8:11], s40 offen offset:512 nt
    v_cvt_pk_bf16_f32 v40, v40, v40
    v_and_b32 v40, s7, v40
    s_waitcnt vmcnt(3)
    buffer_load_dwordx4 v[124:127], v2, s[8:11], s40 offen offset:768 nt
    s_add_u32 s50, s50, 1
    s_and_b32 s53, s50, 63
    s_and_b32 s41, s53, 1
    s_lshl_b32 s41, s41, 12
    s_xor_b32 s40, s49, s41
    s_and_b32 s41, s53, 2
    s_lshl_b32 s41, s41, 16
    s_xor_b32 s40, s40, s41
    s_and_b32 s41, s53, 4
    s_lshl_b32 s41, s41, 14
    s_xor_b32 s40, s40, s41
    s_and_b32 s41, s53, 24
    s_lshl_b32 s41, s41, 15
    s_xor_b32 s40, s40, s41
    s_and_b32 s41, s53, 16
    s_lshl_b32 s41, s41, 10
    s_xor_b32 s40, s40, s41
    s_and_b32 s41, s53, 32
    s_lshl_b32 s41, s41, 9
    s_xor_b32 s40, s40, s41
    v_mul_f32 v40, s42, v40
    v_cvt_pk_bf16_f32 v49, v40, v40
    s_mov_b64 exec, s[54:55]
    ds_write_b16 v26, v49 offset:32
    s_mov_b64 exec, -1
    v_add_u32 v26, 64, v26
    s_mov_b64 exec, 1
    ds_add_rtn_u32 v30, v70, v71 offset:2496
    s_mov_b64 exec, -1
    ds_read_b32 v31, v70 offset:2500
    v_mfma_f32_16x16x32_bf16 v[36:39], v[128:131], v[16:19], 0
    v_mfma_f32_16x16x32_bf16 v[36:39], v[132:135], v[20:23], v[36:39]
    v_mfma_f32_16x16x32_bf16 v[36:39], v[136:139], v[32:35], v[36:39]
    v_mfma_f32_16x16x32_bf16 v[36:39], v[140:143], v[60:63], v[36:39]
    buffer_load_dwordx4 v[128:131], v2, s[8:11], s40 offen offset:0 nt
    s_nop 6
    v_cndmask_b32 v40, v36, v37, s[56:57]
    v_cndmask_b32 v40, v40, v38, s[58:59]
    s_waitcnt vmcnt(4)
    buffer_load_dwordx4 v[132:135], v2, s[8:11], s40 offen offset:256 nt
    v_cndmask_b32 v40, v40, v39, s[60:61]
    s_nop 1
    v_add_f32_dpp v40, v40, v40 quad_perm:[1,0,3,2] row_mask:0xf bank_mask:0xf
    s_nop 1
    v_add_f32_dpp v40, v40, v40 quad_perm:[2,3,0,1] row_mask:0xf bank_mask:0xf
    s_waitcnt vmcnt(4)
    buffer_load_dwordx4 v[136:139], v2, s[8:11], s40 offen offset:512 nt
    v_cvt_pk_bf16_f32 v40, v40, v40
    v_and_b32 v40, s7, v40
    s_waitcnt vmcnt(4)
    buffer_load_dwordx4 v[140:143], v2, s[8:11], s40 offen offset:768 nt
    s_add_u32 s50, s50, 1
    s_and_b32 s53, s50, 63
    s_and_b32 s41, s53, 1
    s_lshl_b32 s41, s41, 12
    s_xor_b32 s40, s49, s41
    s_and_b32 s41, s53, 2
    s_lshl_b32 s41, s41, 16
    s_xor_b32 s40, s40, s41
    s_and_b32 s41, s53, 4
    s_lshl_b32 s41, s41, 14
    s_xor_b32 s40, s40, s41
    s_and_b32 s41, s53, 24
    s_lshl_b32 s41, s41, 15
    s_xor_b32 s40, s40, s41
    s_and_b32 s41, s53, 16
    s_lshl_b32 s41, s41, 10
    s_xor_b32 s40, s40, s41
    s_and_b32 s41, s53, 32
    s_lshl_b32 s41, s41, 9
    s_xor_b32 s40, s40, s41
    v_mul_f32 v40, s42, v40
    v_cvt_pk_bf16_f32 v48, v40, v40
    s_mov_b64 exec, s[54:55]
    ds_write_b16 v26, v48 offset:0
    s_mov_b64 exec, -1
    v_mfma_f32_16x16x32_bf16 v[36:39], v[144:147], v[16:19], 0
    v_mfma_f32_16x16x32_bf16 v[36:39], v[148:151], v[20:23], v[36:39]
    v_mfma_f32_16x16x32_bf16 v[36:39], v[152:155], v[32:35], v[36:39]
    v_mfma_f32_16x16x32_bf16 v[36:39], v[156:159], v[60:63], v[36:39]
    s_waitcnt vmcnt(3)
    buffer_load_dwordx4 v[144:147], v2, s[8:11], s40 offen offset:0 nt
    s_nop 5
    v_cndmask_b32 v40, v36, v37, s[56:57]
    v_cndmask_b32 v40, v40, v38, s[58:59]
    s_waitcnt vmcnt(3)
    buffer_load_dwordx4 v[148:151], v2, s[8:11], s40 offen offset:256 nt
    v_cndmask_b32 v40, v40, v39, s[60:61]
    s_nop 1
    v_add_f32_dpp v40, v40, v40 quad_perm:[1,0,3,2] row_mask:0xf bank_mask:0xf
    s_nop 1
    v_add_f32_dpp v40, v40, v40 quad_perm:[2,3,0,1] row_mask:0xf bank_mask:0xf
    s_waitcnt vmcnt(3)
    buffer_load_dwordx4 v[152:155], v2, s[8:11], s40 offen offset:512 nt
    v_cvt_pk_bf16_f32 v40, v40, v40
    v_and_b32 v40, s7, v40
    s_waitcnt vmcnt(3)
    buffer_load_dwordx4 v[156:159], v2, s[8:11], s40 offen offset:768 nt
    s_add_u32 s50, s50, 1
    s_and_b32 s53, s50, 63
    s_and_b32 s41, s53, 1
    s_lshl_b32 s41, s41, 12
    s_xor_b32 s40, s49, s41
    s_and_b32 s41, s53, 2
    s_lshl_b32 s41, s41, 16
    s_xor_b32 s40, s40, s41
    s_and_b32 s41, s53, 4
    s_lshl_b32 s41, s41, 14
    s_xor_b32 s40, s40, s41
    s_and_b32 s41, s53, 24
    s_lshl_b32 s41, s41, 15
    s_xor_b32 s40, s40, s41
    s_and_b32 s41, s53, 16
    s_lshl_b32 s41, s41, 10
    s_xor_b32 s40, s40, s41
    s_and_b32 s41, s53, 32
    s_lshl_b32 s41, s41, 9
    s_xor_b32 s40, s40, s41
    v_mul_f32 v40, s42, v40
    v_cvt_pk_bf16_f32 v49, v40, v40
    s_mov_b64 exec, s[54:55]
    ds_write_b16 v26, v49 offset:32
    s_mov_b64 exec, -1
    v_add_u32 v26, 64, v26
    s_sub_u32 s44, s44, 1
    s_cmp_eq_u32 s44, 0
    s_cbranch_scc1 L_k_end
    s_waitcnt lgkmcnt(2)
    v_readfirstlane_b32 s43, v31
    v_readfirstlane_b32 s45, v30
    s_nop 0
    s_sub_i32 s45, s45, s51
    s_add_u32 s51, s51, 8
    s_cmp_ge_i32 s45, 3
    s_addc_u32 s43, s43, 0
    s_cmp_le_i32 s45, 0
    s_subb_u32 s43, s43, 0
    s_cmp_eq_u32 s43, 0
    s_cbranch_scc1 L_k0
    s_cmp_eq_u32 s43, 1
    s_cbranch_scc1 L_k1
    s_cmp_eq_u32 s43, 2
    s_cbranch_scc1 L_k2
    s_cmp_eq_u32 s43, 3
    s_cbranch_scc1 L_k3
    s_cmp_eq_u32 s43, 4
    s_cbranch_scc1 L_k4
    s_cmp_eq_u32 s43, 5
    s_cbranch_scc1 L_k5
    s_branch L_k6
L_k2:
    s_mov_b64 exec, 1
    ds_add_u32 v70, v71 offset:2496
    s_mov_b64 exec, -1
    v_mfma_f32_16x16x32_bf16 v[36:39], v[96:99], v[16:19], 0
    v_mfma_f32_16x16x32_bf16 v[36:39], v[100:103], v[20:23], v[36:39]
    v_mfma_f32_16x16x32_bf16 v[36:39], v[104:107], v[32:35], v[36:39]
    v_mfma_f32_16x16x32_bf16 v[36:39], v[108:111], v[60:63], v[36:39]
    s_waitcnt vmcnt(4)
    buffer_load_dwordx4 v[96:99], v2, s[8:11], s40 offen offset:0 nt
    s_nop 5
    v_cndmask_b32 v40, v36, v37, s[56:57]
    v_cndmask_b32 v40, v40, v38, s[58:59]
    s_waitcnt vmcnt(4)
    buffer_load_dwordx4 v[100:103], v2, s[8:11], s40 offen offset:256 nt
    v_cndmask_b32 v40, v40, v39, s[60:61]
    s_nop 1
    v_add_f32_dpp v40, v40, v40 quad_perm:[1,0,3,2] row_mask:0xf bank_mask:0xf
    s_nop 1
    v_add_f32_dpp v40, v40, v40 quad_perm:[2,3,0,1] row_mask:0xf bank_mask:0xf
    s_waitcnt vmcnt(4)
    buffer_load_dwordx4 v[104:107], v2, s[8:11], s40 offen offset:512 nt
    v_cvt_pk_bf16_f32 v40, v40, v40
    v_and_b32 v40, s7, v40
    s_waitcnt vmcnt(4)
    buffer_load_dwordx4 v[108:111], v2, s[8:11], s40 offen offset:768 nt
    s_add_u32 s50, s50, 1
    s_and_b32 s53, s50, 63
    s_and_b32 s41, s53, 1
    s_lshl_b32 s41, s41, 12
    s_xor_b32 s40, s49, s41
    s_and_b32 s41, s53, 2
    s_lshl_b32 s41, s41, 16
    s_xor_b32 s40, s40, s41
    s_and_b32 s41, s53, 4
    s_lshl_b32 s41, s41, 14
    s_xor_b32 s40, s40, s41
    s_and_b32 s41, s53, 24
    s_lshl_b32 s41, s41, 15
    s_xor_b32 s40, s40, s41
    s_and_b32 s41, s53, 16
    s_lshl_b32 s41, s41, 10
    s_xor_b32 s40, s40, s41
    s_and_b32 s41, s53, 32
    s_lshl_b32 s41, s41, 9
    s_xor_b32 s40, s40, s41
    v_mul_f32 v40, s42, v40
    v_cvt_pk_bf16_f32 v48, v40, v40
    s_mov_b64 exec, s[54:55]
    ds_write_b16 v26, v48 offset:0
    s_mov_b64 exec, -1
    v_mfma_f32_16x16x32_bf16 v[36:39], v[112:115], v[16:19], 0
    v_mfma_f32_16x16x32_bf16 v[36:39], v[116:119], v[20:23], v[36:39]
    v_mfma_f32_16x16x32_bf16 v[36:39], v[120:123], v[32:35], v[36:39]
    v_mfma_f32_16x16x32_bf16 v[36:39], v[124:127], v[60:63], v[36:39]
    s_waitcnt vmcnt(4)
    buffer_load_dwordx4 v[112:115], v2, s[8:11], s40 offen offset:0 nt
    s_nop 5
    v_cndmask_b32 v40, v36, v37, s[56:57]
    v_cndmask_b32 v40, v40, v38, s[58:59]
    s_waitcnt vmcnt(4)
    buffer_load_dwordx4 v[116:119], v2, s[8:11], s40 offen offset:256 nt
    v_cndmask_b32 v40, v40, v39, s[60:61]
    s_nop 1
    v_add_f32_dpp v40, v40, v40 quad_perm:[1,0,3,2] row_mask:0xf bank_mask:0xf
    s_nop 1
    v_add_f32_dpp v40, v40, v40 quad_perm:[2,3,0,1] row_mask:0xf bank_mask:0xf
    s_waitcnt vmcnt(4)
    buffer_load_dwordx4 v[120:123], v2, s[8:11], s40 offen offset:512 nt
    v_cvt_pk_bf16_f32 v40, v40, v40
    v_and_b32 v40, s7, v40
    s_waitcnt vmcnt(4)
    buffer_load_dwordx4 v[124:127], v2, s[8:11], s40 offen offset:768 nt
    s_add_u32 s50, s50, 1
    s_and_b32 s53, s50, 63
    s_and_b32 s41, s53, 1
    s_lshl_b32 s41, s41, 12
    s_xor_b32 s40, s49, s41
    s_and_b32 s41, s53, 2
    s_lshl_b32 s41, s41, 16
    s_xor_b32 s40, s40, s41
    s_and_b32 s41, s53, 4
    s_lshl_b32 s41, s41, 14
    s_xor_b32 s40, s40, s41
    s_and_b32 s41, s53, 24
    s_lshl_b32 s41, s41, 15
    s_xor_b32 s40, s40, s41
    s_and_b32 s41, s53, 16
    s_lshl_b32 s41, s41, 10
    s_xor_b32 s40, s40, s41
    s_and_b32 s41, s53, 32
    s_lshl_b32 s41, s41, 9
    s_xor_b32 s40, s40, s41
    v_mul_f32 v40, s42, v40
    v_cvt_pk_bf16_f32 v49, v40, v40
    s_mov_b64 exec, s[54:55]
    ds_write_b16 v26, v49 offset:32
    s_mov_b64 exec, -1
    v_add_u32 v26, 64, v26
    s_mov_b64 exec, 1
    ds_add_rtn_u32 v30, v70, v71 offset:2496
    s_mov_b64 exec, -1
    ds_read_b32 v31, v70 offset:2500
    v_mfma_f32_16x16x32_bf16 v[36:39], v[128:131], v[16:19], 0
    v_mfma_f32_16x16x32_bf16 v[36:39], v[132:135], v[20:23], v[36:39]
    v_mfma_f32_16x16x32_bf16 v[36:39], v[136:139], v[32:35], v[36:39]
    v_mfma_f32_16x16x32_bf16 v[36:39], v[140:143], v[60:63], v[36:39]
    s_waitcnt vmcnt(4)
    buffer_load_dwordx4 v[128:131], v2, s[8:11], s40 offen offset:0 nt
    s_nop 5
    v_cndmask_b32 v40, v36, v37, s[56:57]
    v_cndmask_b32 v40, v40, v38, s[58:59]
    s_waitcnt vmcnt(4)
    buffer_load_dwordx4 v[132:135], v2, s[8:11], s40 offen offset:256 nt
    v_cndmask_b32 v40, v40, v39, s[60:61]
    s_nop 1
    v_add_f32_dpp v40, v40, v40 quad_perm:[1,0,3,2] row_mask:0xf bank_mask:0xf
    s_nop 1
    v_add_f32_dpp v40, v40, v40 quad_perm:[2,3,0,1] row_mask:0xf bank_mask:0xf
    s_waitcnt vmcnt(4)
    buffer_load_dwordx4 v[136:139], v2, s[8:11], s40 offen offset:512 nt
    v_cvt_pk_bf16_f32 v40, v40, v40
    v_and_b32 v40, s7, v40
    s_waitcnt vmcnt(4)
    buffer_load_dwordx4 v[140:143], v2, s[8:11], s40 offen offset:768 nt
    s_add_u32 s50, s50, 1
    s_and_b32 s53, s50, 63
    s_and_b32 s41, s53, 1
    s_lshl_b32 s41, s41, 12
    s_xor_b32 s40, s49, s41
    s_and_b32 s41, s53, 2
    s_lshl_b32 s41, s41, 16
    s_xor_b32 s40, s40, s41
    s_and_b32 s41, s53, 4
    s_lshl_b32 s41, s41, 14
    s_xor_b32 s40, s40, s41
    s_and_b32 s41, s53, 24
    s_lshl_b32 s41, s41, 15
    s_xor_b32 s40, s40, s41
    s_and_b32 s41, s53, 16
    s_lshl_b32 s41, s41, 10
    s_xor_b32 s40, s40, s41
    s_and_b32 s41, s53, 32
    s_lshl_b32 s41, s41, 9
    s_xor_b32 s40, s40, s41
    v_mul_f32 v40, s42, v40
    v_cvt_pk_bf16_f32 v48, v40, v40
    s_mov_b64 exec, s[54:55]
    ds_write_b16 v26, v48 offset:0
    s_mov_b64 exec, -1
    v_mfma_f32_16x16x32_bf16 v[36:39], v[144:147], v[16:19], 0
    v_mfma_f32_16x16x32_bf16 v[36:39], v[148:151], v[20:23], v[36:39]
    v_mfma_f32_16x16x32_bf16 v[36:39], v[152:155], v[32:35], v[36:39]
    v_mfma_f32_16x16x32_bf16 v[36:39], v[156:159], v[60:63], v[36:39]
    s_waitcnt vmcnt(4)
    buffer_load_dwordx4 v[144:147], v2, s[8:11], s40 offen offset:0 nt
    s_nop 5
    v_cndmask_b32 v40, v36, v37, s[56:57]
    v_cndmask_b32 v40, v40, v38, s[58:59]
    s_waitcnt vmcnt(4)
    buffer_load_dwordx4 v[148:151], v2, s[8:11], s40 offen offset:256 nt
    v_cndmask_b32 v40, v40, v39, s[60:61]
    s_nop 1
    v_add_f32_dpp v40, v40, v40 quad_perm:[1,0,3,2] row_mask:0xf bank_mask:0xf
    s_nop 1
    v_add_f32_dpp v40, v40, v40 quad_perm:[2,3,0,1] row_mask:0xf bank_mask:0xf
    s_waitcnt vmcnt(4)
    buffer_load_dwordx4 v[152:155], v2, s[8:11], s40 offen offset:512 nt
    v_cvt_pk_bf16_f32 v40, v40, v40
    v_and_b32 v40, s7, v40
    s_waitcnt vmcnt(4)
    buffer_load_dwordx4 v[156:159], v2, s[8:11], s40 offen offset:768 nt
    s_add_u32 s50, s50, 1
    s_and_b32 s53, s50, 63
    s_and_b32 s41, s53, 1
    s_lshl_b32 s41, s41, 12
    s_xor_b32 s40, s49, s41
    s_and_b32 s41, s53, 2
    s_lshl_b32 s41, s41, 16
    s_xor_b32 s40, s40, s41
    s_and_b32 s41, s53, 4
    s_lshl_b32 s41, s41, 14
    s_xor_b32 s40, s40, s41
    s_and_b32 s41, s53, 24
    s_lshl_b32 s41, s41, 15
    s_xor_b32 s40, s40, s41
    s_and_b32 s41, s53, 16
    s_lshl_b32 s41, s41, 10
    s_xor_b32 s40, s40, s41
    s_and_b32 s41, s53, 32
    s_lshl_b32 s41, s41, 9
    s_xor_b32 s40, s40, s41
    v_mul_f32 v40, s42, v40
    v_cvt_pk_bf16_f32 v49, v40, v40
    s_mov_b64 exec, s[54:55]
    ds_write_b16 v26, v49 offset:32
    s_mov_b64 exec, -1
    v_add_u32 v26, 64, v26
    s_sub_u32 s44, s44, 1
    s_cmp_eq_u32 s44, 0
    s_cbranch_scc1 L_k_end
    s_waitcnt lgkmcnt(2)
    v_readfirstlane_b32 s43, v31
    v_readfirstlane_b32 s45, v30
    s_nop 0
    s_sub_i32 s45, s45, s51
    s_add_u32 s51, s51, 8
    s_cmp_ge_i32 s45, 3
    s_addc_u32 s43, s43, 0
    s_cmp_le_i32 s45, 0
    s_subb_u32 s43, s43, 0
    s_cmp_eq_u32 s43, 0
    s_cbranch_scc1 L_k0
    s_cmp_eq_u32 s43, 1
    s_cbranch_scc1 L_k1
    s_cmp_eq_u32 s43, 2
    s_cbranch_scc1 L_k2
    s_cmp_eq_u32 s43, 3
    s_cbranch_scc1 L_k3
    s_cmp_eq_u32 s43, 4
    s_cbranch_scc1 L_k4
    s_cmp_eq_u32 s43, 5
    s_cbranch_scc1 L_k5
    s_branch L_k6
L_k3:
    s_mov_b64 exec, 1
    ds_add_u32 v70, v71 offset:2496
    s_mov_b64 exec, -1
    v_mfma_f32_16x16x32_bf16 v[36:39], v[96:99], v[16:19], 0
    v_mfma_f32_16x16x32_bf16 v[36:39], v[100:103], v[20:23], v[36:39]
    v_mfma_f32_16x16x32_bf16 v[36:39], v[104:107], v[32:35], v[36:39]
    v_mfma_f32_16x16x32_bf16 v[36:39], v[108:111], v[60:63], v[36:39]
    s_waitcnt vmcnt(5)
    buffer_load_dwordx4 v[96:99], v2, s[8:11], s40 offen offset:0 nt
    s_nop 5
    v_cndmask_b32 v40, v36, v37, s[56:57]
    v_cndmask_b32 v40, v40, v38, s[58:59]
    s_waitcnt vmcnt(5)
    buffer_load_dwordx4 v[100:103], v2, s[8:11], s40 offen offset:256 nt
    v_cndmask_b32 v40, v40, v39, s[60:61]
    s_nop 1
    v_add_f32_dpp v40, v40, v40 quad_perm:[1,0,3,2] row_mask:0xf bank_mask:0xf
    s_nop 1
    v_add_f32_dpp v40, v40, v40 quad_perm:[2,3,0,1] row_mask:0xf bank_mask:0xf
    s_waitcnt vmcnt(5)
    buffer_load_dwordx4 v[104:107], v2, s[8:11], s40 offen offset:512 nt
    v_cvt_pk_bf16_f32 v40, v40, v40
    v_and_b32 v40, s7, v40
    s_waitcnt vmcnt(5)
    buffer_load_dwordx4 v[108:111], v2, s[8:11], s40 offen offset:768 nt
    s_add_u32 s50, s50, 1
    s_and_b32 s53, s50, 63
    s_and_b32 s41, s53, 1
    s_lshl_b32 s41, s41, 12
    s_xor_b32 s40, s49, s41
    s_and_b32 s41, s53, 2
    s_lshl_b32 s41, s41, 16
    s_xor_b32 s40, s40, s41
    s_and_b32 s41, s53, 4
    s_lshl_b32 s41, s41, 14
    s_xor_b32 s40, s40, s41
    s_and_b32 s41, s53, 24
    s_lshl_b32 s41, s41, 15
    s_xor_b32 s40, s40, s41
    s_and_b32 s41, s53, 16
    s_lshl_b32 s41, s41, 10
    s_xor_b32 s40, s40, s41
    s_and_b32 s41, s53, 32
    s_lshl_b32 s41, s41, 9
    s_xor_b32 s40, s40, s41
    v_mul_f32 v40, s42, v40
    v_cvt_pk_bf16_f32 v48, v40, v40
    s_mov_b64 exec, s[54:55]
    ds_write_b16 v26, v48 offset:0
    s_mov_b64 exec, -1
    v_mfma_f32_16x16x32_bf16 v[36:39], v[112:115], v[16:19], 0
    v_mfma_f32_16x16x32_bf16 v[36:39], v[116:119], v[20:23], v[36:39]
    v_mfma_f32_16x16x32_bf16 v[36:39], v[120:123], v[32:35], v[36:39]
    v_mfma_f32_16x16x32_bf16 v[36:39], v[124:127], v[60:63], v[36:39]
    s_waitcnt vmcnt(4)
    buffer_load_dwordx4 v[112:115], v2, s[8:11], s40 offen offset:0 nt
    s_nop 5
    v_cndmask_b32 v40, v36, v37, s[56:57]
    v_cndmask_b32 v40, v40, v38, s[58:59]
    s_waitcnt vmcnt(4)
    buffer_load_dwordx4 v[116:119], v2, s[8:11], s40 offen offset:256 nt
    v_cndmask_b32 v40, v40, v39, s[60:61]
    s_nop 1
    v_add_f32_dpp v40, v40, v40 quad_perm:[1,0,3,2] row_mask:0xf bank_mask:0xf
    s_nop 1
    v_add_f32_dpp v40, v40, v40 quad_perm:[2,3,0,1] row_mask:0xf bank_mask:0xf
    s_waitcnt vmcnt(4)
    buffer_load_dwordx4 v[120:123], v2, s[8:11], s40 offen offset:512 nt
    v_cvt_pk_bf16_f32 v40, v40, v40
    v_and_b32 v40, s7, v40
    s_waitcnt vmcnt(4)
    buffer_load_dwordx4 v[124:127], v2, s[8:11], s40 offen offset:768 nt
    s_add_u32 s50, s50, 1
    s_and_b32 s53, s50, 63
    s_and_b32 s41, s53, 1
    s_lshl_b32 s41, s41, 12
    s_xor_b32 s40, s49, s41
    s_and_b32 s41, s53, 2
    s_lshl_b32 s41, s41, 16
    s_xor_b32 s40, s40, s41
    s_and_b32 s41, s53, 4
    s_lshl_b32 s41, s41, 14
    s_xor_b32 s40, s40, s41
    s_and_b32 s41, s53, 24
    s_lshl_b32 s41, s41, 15
    s_xor_b32 s40, s40, s41
    s_and_b32 s41, s53, 16
    s_lshl_b32 s41, s41, 10
    s_xor_b32 s40, s40, s41
    s_and_b32 s41, s53, 32
    s_lshl_b32 s41, s41, 9
    s_xor_b32 s40, s40, s41
    v_mul_f32 v40, s42, v40
    v_cvt_pk_bf16_f32 v49, v40, v40
    s_mov_b64 exec, s[54:55]
    ds_write_b16 v26, v49 offset:32
    s_mov_b64 exec, -1
    v_add_u32 v26, 64, v26
    s_mov_b64 exec, 1
    ds_add_rtn_u32 v30, v70, v71 offset:2496
    s_mov_b64 exec, -1
    ds_read_b32 v31, v70 offset:2500
    v_mfma_f32_16x16x32_bf16 v[36:39], v[128:131], v[16:19], 0
    v_mfma_f32_16x16x32_bf16 v[36:39], v[132:135], v[20:23], v[36:39]
    v_mfma_f32_16x16x32_bf16 v[36:39], v[136:139], v[32:35], v[36:39]
    v_mfma_f32_16x16x32_bf16 v[36:39], v[140:143], v[60:63], v[36:39]
    buffer_load_dwordx4 v[128:131], v2, s[8:11], s40 offen offset:0 nt
    s_nop 6
    v_cndmask_b32 v40, v36, v37, s[56:57]
    v_cndmask_b32 v40, v40, v38, s[58:59]
    s_waitcnt vmcnt(5)
    buffer_load_dwordx4 v[132:135], v2, s[8:11], s40 offen offset:256 nt
    v_cndmask_b32 v40, v40, v39, s[60:61]
    s_nop 1
    v_add_f32_dpp v40, v40, v40 quad_perm:[1,0,3,2] row_mask:0xf bank_mask:0xf
    s_nop 1
    v_add_f32_dpp v40, v40, v40 quad_perm:[2,3,0,1] row_mask:0xf bank_mask:0xf
    s_waitcnt vmcnt(5)
    buffer_load_dwordx4 v[136:139], v2, s[8:11], s40 offen offset:512 nt
    v_cvt_pk_bf16_f32 v40, v40, v40
    v_and_b32 v40, s7, v40
    s_waitcnt vmcnt(5)
    buffer_load_dwordx4 v[140:143], v2, s[8:11], s40 offen offset:768 nt
    s_add_u32 s50, s50, 1
    s_and_b32 s53, s50, 63
    s_and_b32 s41, s53, 1
    s_lshl_b32 s41, s41, 12
    s_xor_b32 s40, s49, s41
    s_and_b32 s41, s53, 2
    s_lshl_b32 s41, s41, 16
    s_xor_b32 s40, s40, s41
    s_and_b32 s41, s53, 4
    s_lshl_b32 s41, s41, 14
    s_xor_b32 s40, s40, s41
    s_and_b32 s41, s53, 24
    s_lshl_b32 s41, s41, 15
    s_xor_b32 s40, s40, s41
    s_and_b32 s41, s53, 16
    s_lshl_b32 s41, s41, 10
    s_xor_b32 s40, s40, s41
    s_and_b32 s41, s53, 32
    s_lshl_b32 s41, s41, 9
    s_xor_b32 s40, s40, s41
    v_mul_f32 v40, s42, v40
    v_cvt_pk_bf16_f32 v48, v40, v40
    s_mov_b64 exec, s[54:55]
    ds_write_b16 v26, v48 offset:0
    s_mov_b64 exec, -1
    v_mfma_f32_16x16x32_bf16 v[36:39], v[144:147], v[16:19], 0
    v_mfma_f32_16x16x32_bf16 v[36:39], v[148:151], v[20:23], v[36:39]
    v_mfma_f32_16x16x32_bf16 v[36:39], v[152:155], v[32:35], v[36:39]
    v_mfma_f32_16x16x32_bf16 v[36:39], v[156:159], v[60:63], v[36:39]
    s_waitcnt vmcnt(4)
    buffer_load_dwordx4 v[144:147], v2, s[8:11], s40 offen offset:0 nt
    s_nop 5
    v_cndmask_b32 v40, v36, v37, s[56:57]
    v_cndmask_b32 v40, v40, v38, s[58:59]
    s_waitcnt vmcnt(4)
    buffer_load_dwordx4 v[148:151], v2, s[8:11], s40 offen offset:256 nt
    v_cndmask_b32 v40, v40, v39, s[60:61]
    s_nop 1
    v_add_f32_dpp v40, v40, v40 quad_perm:[1,0,3,2] row_mask:0xf bank_mask:0xf
    s_nop 1
    v_add_f32_dpp v40, v40, v40 quad_perm:[2,3,0,1] row_mask:0xf bank_mask:0xf
    s_waitcnt vmcnt(4)
    buffer_load_dwordx4 v[152:155], v2, s[8:11], s40 offen offset:512 nt
    v_cvt_pk_bf16_f32 v40, v40, v40
    v_and_b32 v40, s7, v40
    s_waitcnt vmcnt(4)
    buffer_load_dwordx4 v[156:159], v2, s[8:11], s40 offen offset:768 nt
    s_add_u32 s50, s50, 1
    s_and_b32 s53, s50, 63
    s_and_b32 s41, s53, 1
    s_lshl_b32 s41, s41, 12
    s_xor_b32 s40, s49, s41
    s_and_b32 s41, s53, 2
    s_lshl_b32 s41, s41, 16
    s_xor_b32 s40, s40, s41
    s_and_b32 s41, s53, 4
    s_lshl_b32 s41, s41, 14
    s_xor_b32 s40, s40, s41
    s_and_b32 s41, s53, 24
    s_lshl_b32 s41, s41, 15
    s_xor_b32 s40, s40, s41
    s_and_b32 s41, s53, 16
    s_lshl_b32 s41, s41, 10
    s_xor_b32 s40, s40, s41
    s_and_b32 s41, s53, 32
    s_lshl_b32 s41, s41, 9
    s_xor_b32 s40, s40, s41
    v_mul_f32 v40, s42, v40
    v_cvt_pk_bf16_f32 v49, v40, v40
    s_mov_b64 exec, s[54:55]
    ds_write_b16 v26, v49 offset:32
    s_mov_b64 exec, -1
    v_add_u32 v26, 64, v26
    s_sub_u32 s44, s44, 1
    s_cmp_eq_u32 s44, 0
    s_cbranch_scc1 L_k_end
    s_waitcnt lgkmcnt(2)
    v_readfirstlane_b32 s43, v31
    v_readfirstlane_b32 s45, v30
    s_nop 0
    s_sub_i32 s45, s45, s51
    s_add_u32 s51, s51, 8
    s_cmp_ge_i32 s45, 3
    s_addc_u32 s43, s43, 0
    s_cmp_le_i32 s45, 0
    s_subb_u32 s43, s43, 0
    s_cmp_eq_u32 s43, 0
    s_cbranch_scc1 L_k0
    s_cmp_eq_u32 s43, 1
    s_cbranch_scc1 L_k1
    s_cmp_eq_u32 s43, 2
    s_cbranch_scc1 L_k2
    s_cmp_eq_u32 s43, 3
    s_cbranch_scc1 L_k3
    s_cmp_eq_u32 s43, 4
    s_cbranch_scc1 L_k4
    s_cmp_eq_u32 s43, 5
    s_cbranch_scc1 L_k5
    s_branch L_k6
L_k4:
    s_mov_b64 exec, 1
    ds_add_u32 v70, v71 offset:2496
    s_mov_b64 exec, -1
    v_mfma_f32_16x16x32_bf16 v[36:39], v[96:99], v[16:19], 0
    v_mfma_f32_16x16x32_bf16 v[36:39], v[100:103], v[20:23], v[36:39]
    v_mfma_f32_16x16x32_bf16 v[36:39], v[104:107], v[32:35], v[36:39]
    v_mfma_f32_16x16x32_bf16 v[36:39], v[108:111], v[60:63], v[36:39]
    s_waitcnt vmcnt(5)
    buffer_load_dwordx4 v[96:99], v2, s[8:11], s40 offen offset:0 nt
    s_nop 5
    v_cndmask_b32 v40, v36, v37, s[56:57]
    v_cndmask_b32 v40, v40, v38, s[58:59]
    s_waitcnt vmcnt(5)
    buffer_load_dwordx4 v[100:103], v2, s[8:11], s40 offen offset:256 nt
    v_cndmask_b32 v40, v40, v39, s[60:61]
    s_nop 1
    v_add_f32_dpp v40, v40, v40 quad_perm:[1,0,3,2] row_mask:0xf bank_mask:0xf
    s_nop 1
    v_add_f32_dpp v40, v40, v40 quad_perm:[2,3,0,1] row_mask:0xf bank_mask:0xf
    s_waitcnt vmcnt(5)
    buffer_load_dwordx4 v[104:107], v2, s[8:11], s40 offen offset:512 nt
    v_cvt_pk_bf16_f32 v40, v40, v40
    v_and_b32 v40, s7, v40
    s_waitcnt vmcnt(5)
    buffer_load_dwordx4 v[108:111], v2, s[8:11], s40 offen offset:768 nt
    s_add_u32 s50, s50, 1
    s_and_b32 s53, s50, 63
    s_and_b32 s41, s53, 1
    s_lshl_b32 s41, s41, 12
    s_xor_b32 s40, s49, s41
    s_and_b32 s41, s53, 2
    s_lshl_b32 s41, s41, 16
    s_xor_b32 s40, s40, s41
    s_and_b32 s41, s53, 4
    s_lshl_b32 s41, s41, 14
    s_xor_b32 s40, s40, s41
    s_and_b32 s41, s53, 24
    s_lshl_b32 s41, s41, 15
    s_xor_b32 s40, s40, s41
    s_and_b32 s41, s53, 16
    s_lshl_b32 s41, s41, 10
    s_xor_b32 s40, s40, s41
    s_and_b32 s41, s53, 32
    s_lshl_b32 s41, s41, 9
    s_xor_b32 s40, s40, s41
    v_mul_f32 v40, s42, v40
    v_cvt_pk_bf16_f32 v48, v40, v40
    s_mov_b64 exec, s[54:55]
    ds_write_b16 v26, v48 offset:0
    s_mov_b64 exec, -1
    v_mfma_f32_16x16x32_bf16 v[36:39], v[112:115], v[16:19], 0
    v_mfma_f32_16x16x32_bf16 v[36:39], v[116:119], v[20:23], v[36:39]
    v_mfma_f32_16x16x32_bf16 v[36:39], v[120:123], v[32:35], v[36:39]
    v_mfma_f32_16x16x32_bf16 v[36:39], v[124:127], v[60:63], v[36:39]
    s_waitcnt vmcnt(5)
    buffer_load_dwordx4 v[112:115], v2, s[8:11], s40 offen offset:0 nt
    s_nop 5
    v_cndmask_b32 v40, v36, v37, s[56:57]
    v_cndmask_b32 v40, v40, v38, s[58:59]
    s_waitcnt vmcnt(5)
    buffer_load_dwordx4 v[116:119], v2, s[8:11], s40 offen offset:256 nt
    v_cndmask_b32 v40, v40, v39, s[60:61]
    s_nop 1
    v_add_f32_dpp v40, v40, v40 quad_perm:[1,0,3,2] row_mask:0xf bank_mask:0xf
    s_nop 1
    v_add_f32_dpp v40, v40, v40 quad_perm:[2,3,0,1] row_mask:0xf bank_mask:0xf
    s_waitcnt vmcnt(5)
    buffer_load_dwordx4 v[120:123], v2, s[8:11], s40 offen offset:512 nt
    v_cvt_pk_bf16_f32 v40, v40, v40
    v_and_b32 v40, s7, v40
    s_waitcnt vmcnt(5)
    buffer_load_dwordx4 v[124:127], v2, s[8:11], s40 offen offset:768 nt
    s_add_u32 s50, s50, 1
    s_and_b32 s53, s50, 63
    s_and_b32 s41, s53, 1
    s_lshl_b32 s41, s41, 12
    s_xor_b32 s40, s49, s41
    s_and_b32 s41, s53, 2
    s_lshl_b32 s41, s41, 16
    s_xor_b32 s40, s40, s41
    s_and_b32 s41, s53, 4
    s_lshl_b32 s41, s41, 14
    s_xor_b32 s40, s40, s41
    s_and_b32 s41, s53, 24
    s_lshl_b32 s41, s41, 15
    s_xor_b32 s40, s40, s41
    s_and_b32 s41, s53, 16
    s_lshl_b32 s41, s41, 10
    s_xor_b32 s40, s40, s41
    s_and_b32 s41, s53, 32
    s_lshl_b32 s41, s41, 9
    s_xor_b32 s40, s40, s41
    v_mul_f32 v40, s42, v40
    v_cvt_pk_bf16_f32 v49, v40, v40
    s_mov_b64 exec, s[54:55]
    ds_write_b16 v26, v49 offset:32
    s_mov_b64 exec, -1
    v_add_u32 v26, 64, v26
    s_mov_b64 exec, 1
    ds_add_rtn_u32 v30, v70, v71 offset:2496
    s_mov_b64 exec, -1
    ds_read_b32 v31, v70 offset:2500
    v_mfma_f32_16x16x32_bf16 v[36:39], v[128:131], v[16:19], 0
    v_mfma_f32_16x16x32_bf16 v[36:39], v[132:135], v[20:23], v[36:39]
    v_mfma_f32_16x16x32_bf16 v[36:39], v[136:139], v[32:35], v[36:39]
    v_mfma_f32_16x16x32_bf16 v[36:39], v[140:143], v[60:63], v[36:39]
    s_waitcnt vmcnt(5)
    buffer_load_dwordx4 v[128:131], v2, s[8:11], s40 offen offset:0 nt
    s_nop 5
    v_cndmask_b32 v40, v36, v37, s[56:57]
    v_cndmask_b32 v40, v40, v38, s[58:59]
    s_waitcnt vmcnt(5)
    buffer_load_dwordx4 v[132:135], v2, s[8:11], s40 offen offset:256 nt
    v_cndmask_b32 v40, v40, v39, s[60:61]
    s_nop 1
    v_add_f32_dpp v40, v40, v40 quad_perm:[1,0,3,2] row_mask:0xf bank_mask:0xf
    s_nop 1
    v_add_f32_dpp v40, v40, v40 quad_perm:[2,3,0,1] row_mask:0xf bank_mask:0xf
    s_waitcnt vmcnt(5)
    buffer_load_dwordx4 v[136:139], v2, s[8:11], s40 offen offset:512 nt
    v_cvt_pk_bf16_f32 v40, v40, v40
    v_and_b32 v40, s7, v40
    s_waitcnt vmcnt(5)
    buffer_load_dwordx4 v[140:143], v2, s[8:11], s40 offen offset:768 nt
    s_add_u32 s50, s50, 1
    s_and_b32 s53, s50, 63
    s_and_b32 s41, s53, 1
    s_lshl_b32 s41, s41, 12
    s_xor_b32 s40, s49, s41
    s_and_b32 s41, s53, 2
    s_lshl_b32 s41, s41, 16
    s_xor_b32 s40, s40, s41
    s_and_b32 s41, s53, 4
    s_lshl_b32 s41, s41, 14
    s_xor_b32 s40, s40, s41
    s_and_b32 s41, s53, 24
    s_lshl_b32 s41, s41, 15
    s_xor_b32 s40, s40, s41
    s_and_b32 s41, s53, 16
    s_lshl_b32 s41, s41, 10
    s_xor_b32 s40, s40, s41
    s_and_b32 s41, s53, 32
    s_lshl_b32 s41, s41, 9
    s_xor_b32 s40, s40, s41
    v_mul_f32 v40, s42, v40
    v_cvt_pk_bf16_f32 v48, v40, v40
    s_mov_b64 exec, s[54:55]
    ds_write_b16 v26, v48 offset:0
    s_mov_b64 exec, -1
    v_mfma_f32_16x16x32_bf16 v[36:39], v[144:147], v[16:19], 0
    v_mfma_f32_16x16x32_bf16 v[36:39], v[148:151], v[20:23], v[36:39]
    v_mfma_f32_16x16x32_bf16 v[36:39], v[152:155], v[32:35], v[36:39]
    v_mfma_f32_16x16x32_bf16 v[36:39], v[156:159], v[60:63], v[36:39]
    s_waitcnt vmcnt(5)
    buffer_load_dwordx4 v[144:147], v2, s[8:11], s40 offen offset:0 nt
    s_nop 5
    v_cndmask_b32 v40, v36, v37, s[56:57]
    v_cndmask_b32 v40, v40, v38, s[58:59]
    s_waitcnt vmcnt(5)
    buffer_load_dwordx4 v[148:151], v2, s[8:11], s40 offen offset:256 nt
    v_cndmask_b32 v40, v40, v39, s[60:61]
    s_nop 1
    v_add_f32_dpp v40, v40, v40 quad_perm:[1,0,3,2] row_mask:0xf bank_mask:0xf
    s_nop 1
    v_add_f32_dpp v40, v40, v40 quad_perm:[2,3,0,1] row_mask:0xf bank_mask:0xf
    s_waitcnt vmcnt(5)
    buffer_load_dwordx4 v[152:155], v2, s[8:11], s40 offen offset:512 nt
    v_cvt_pk_bf16_f32 v40, v40, v40
    v_and_b32 v40, s7, v40
    s_waitcnt vmcnt(5)
    buffer_load_dwordx4 v[156:159], v2, s[8:11], s40 offen offset:768 nt
    s_add_u32 s50, s50, 1
    s_and_b32 s53, s50, 63
    s_and_b32 s41, s53, 1
    s_lshl_b32 s41, s41, 12
    s_xor_b32 s40, s49, s41
    s_and_b32 s41, s53, 2
    s_lshl_b32 s41, s41, 16
    s_xor_b32 s40, s40, s41
    s_and_b32 s41, s53, 4
    s_lshl_b32 s41, s41, 14
    s_xor_b32 s40, s40, s41
    s_and_b32 s41, s53, 24
    s_lshl_b32 s41, s41, 15
    s_xor_b32 s40, s40, s41
    s_and_b32 s41, s53, 16
    s_lshl_b32 s41, s41, 10
    s_xor_b32 s40, s40, s41
    s_and_b32 s41, s53, 32
    s_lshl_b32 s41, s41, 9
    s_xor_b32 s40, s40, s41
    v_mul_f32 v40, s42, v40
    v_cvt_pk_bf16_f32 v49, v40, v40
    s_mov_b64 exec, s[54:55]
    ds_write_b16 v26, v49 offset:32
    s_mov_b64 exec, -1
    v_add_u32 v26, 64, v26
    s_sub_u32 s44, s44, 1
    s_cmp_eq_u32 s44, 0
    s_cbranch_scc1 L_k_end
    s_waitcnt lgkmcnt(2)
    v_readfirstlane_b32 s43, v31
    v_readfirstlane_b32 s45, v30
    s_nop 0
    s_sub_i32 s45, s45, s51
    s_add_u32 s51, s51, 8
    s_cmp_ge_i32 s45, 3
    s_addc_u32 s43, s43, 0
    s_cmp_le_i32 s45, 0
    s_subb_u32 s43, s43, 0
    s_cmp_eq_u32 s43, 0
    s_cbranch_scc1 L_k0
    s_cmp_eq_u32 s43, 1
    s_cbranch_scc1 L_k1
    s_cmp_eq_u32 s43, 2
    s_cbranch_scc1 L_k2
    s_cmp_eq_u32 s43, 3
    s_cbranch_scc1 L_k3
    s_cmp_eq_u32 s43, 4
    s_cbranch_scc1 L_k4
    s_cmp_eq_u32 s43, 5
    s_cbranch_scc1 L_k5
    s_branch L_k6
L_k5:
    s_mov_b64 exec, 1
    ds_add_u32 v70, v71 offset:2496
    s_mov_b64 exec, -1
    v_mfma_f32_16x16x32_bf16 v[36:39], v[96:99], v[16:19], 0
    v_mfma_f32_16x16x32_bf16 v[36:39], v[100:103], v[20:23], v[36:39]
    v_mfma_f32_16x16x32_bf16 v[36:39], v[104:107], v[32:35], v[36:39]
    v_mfma_f32_16x16x32_bf16 v[36:39], v[108:111], v[60:63], v[36:39]
    s_waitcnt vmcnt(6)
    buffer_load_dwordx4 v[96:99], v2, s[8:11], s40 offen offset:0 nt
    s_nop 5
    v_cndmask_b32 v40, v36, v37, s[56:57]
    v_cndmask_b32 v40, v40, v38, s[58:59]
    s_waitcnt vmcnt(6)
    buffer_load_dwordx4 v[100:103], v2, s[8:11], s40 offen offset:256 nt
    v_cndmask_b32 v40, v40, v39, s[60:61]
    s_nop 1
    v_add_f32_dpp v40, v40, v40 quad_perm:[1,0,3,2] row_mask:0xf bank_mask:0xf
    s_nop 1
    v_add_f32_dpp v40, v40, v40 quad_perm:[2,3,0,1] row_mask:0xf bank_mask:0xf
    s_waitcnt vmcnt(6)
    buffer_load_dwordx4 v[104:107], v2, s[8:11], s40 offen offset:512 nt
    v_cvt_pk_bf16_f32 v40, v40, v40
    v_and_b32 v40, s7, v40
    s_waitcnt vmcnt(6)
    buffer_load_dwordx4 v[108:111], v2, s[8:11], s40 offen offset:768 nt
    s_add_u32 s50, s50, 1
    s_and_b32 s53, s50, 63
    s_and_b32 s41, s53, 1
    s_lshl_b32 s41, s41, 12
    s_xor_b32 s40, s49, s41
    s_and_b32 s41, s53, 2
    s_lshl_b32 s41, s41, 16
    s_xor_b32 s40, s40, s41
    s_and_b32 s41, s53, 4
    s_lshl_b32 s41, s41, 14
    s_xor_b32 s40, s40, s41
    s_and_b32 s41, s53, 24
    s_lshl_b32 s41, s41, 15
    s_xor_b32 s40, s40, s41
    s_and_b32 s41, s53, 16
    s_lshl_b32 s41, s41, 10
    s_xor_b32 s40, s40, s41
    s_and_b32 s41, s53, 32
    s_lshl_b32 s41, s41, 9
    s_xor_b32 s40, s40, s41
    v_mul_f32 v40, s42, v40
    v_cvt_pk_bf16_f32 v48, v40, v40
    s_mov_b64 exec, s[54:55]
    ds_write_b16 v26, v48 offset:0
    s_mov_b64 exec, -1
    v_mfma_f32_16x16x32_bf16 v[36:39], v[112:115], v[16:19], 0
    v_mfma_f32_16x16x32_bf16 v[36:39], v[116:119], v[20:23], v[36:39]
    v_mfma_f32_16x16x32_bf16 v[36:39], v[120:123], v[32:35], v[36:39]
    v_mfma_f32_16x16x32_bf16 v[36:39], v[124:127], v[60:63], v[36:39]
    s_waitcnt vmcnt(6)
    buffer_load_dwordx4 v[112:115], v2, s[8:11], s40 offen offset:0 nt
    s_nop 5
    v_cndmask_b32 v40, v36, v37, s[56:57]
    v_cndmask_b32 v40, v40, v38, s[58:59]
    s_waitcnt vmcnt(6)
    buffer_load_dwordx4 v[116:119], v2, s[8:11], s40 offen offset:256 nt
    v_cndmask_b32 v40, v40, v39, s[60:61]
    s_nop 1
    v_add_f32_dpp v40, v40, v40 quad_perm:[1,0,3,2] row_mask:0xf bank_mask:0xf
    s_nop 1
    v_add_f32_dpp v40, v40, v40 quad_perm:[2,3,0,1] row_mask:0xf bank_mask:0xf
    s_waitcnt vmcnt(6)
    buffer_load_dwordx4 v[120:123], v2, s[8:11], s40 offen offset:512 nt
    v_cvt_pk_bf16_f32 v40, v40, v40
    v_and_b32 v40, s7, v40
    s_waitcnt vmcnt(6)
    buffer_load_dwordx4 v[124:127], v2, s[8:11], s40 offen offset:768 nt
    s_add_u32 s50, s50, 1
    s_and_b32 s53, s50, 63
    s_and_b32 s41, s53, 1
    s_lshl_b32 s41, s41, 12
    s_xor_b32 s40, s49, s41
    s_and_b32 s41, s53, 2
    s_lshl_b32 s41, s41, 16
    s_xor_b32 s40, s40, s41
    s_and_b32 s41, s53, 4
    s_lshl_b32 s41, s41, 14
    s_xor_b32 s40, s40, s41
    s_and_b32 s41, s53, 24
    s_lshl_b32 s41, s41, 15
    s_xor_b32 s40, s40, s41
    s_and_b32 s41, s53, 16
    s_lshl_b32 s41, s41, 10
    s_xor_b32 s40, s40, s41
    s_and_b32 s41, s53, 32
    s_lshl_b32 s41, s41, 9
    s_xor_b32 s40, s40, s41
    v_mul_f32 v40, s42, v40
    v_cvt_pk_bf16_f32 v49, v40, v40
    s_mov_b64 exec, s[54:55]
    ds_write_b16 v26, v49 offset:32
    s_mov_b64 exec, -1
    v_add_u32 v26, 64, v26
    s_mov_b64 exec, 1
    ds_add_rtn_u32 v30, v70, v71 offset:2496
    s_mov_b64 exec, -1
    ds_read_b32 v31, v70 offset:2500
    v_mfma_f32_16x16x32_bf16 v[36:39], v[128:131], v[16:19], 0
    v_mfma_f32_16x16x32_bf16 v[36:39], v[132:135], v[20:23], v[36:39]
    v_mfma_f32_16x16x32_bf16 v[36:39], v[136:139], v[32:35], v[36:39]
    v_mfma_f32_16x16x32_bf16 v[36:39], v[140:143], v[60:63], v[36:39]
    s_waitcnt vmcnt(6)
    buffer_load_dwordx4 v[128:131], v2, s[8:11], s40 offen offset:0 nt
    s_nop 5
    v_cndmask_b32 v40, v36, v37, s[56:57]
    v_cndmask_b32 v40, v40, v38, s[58:59]
    s_waitcnt vmcnt(6)
    buffer_load_dwordx4 v[132:135], v2, s[8:11], s40 offen offset:256 nt
    v_cndmask_b32 v40, v40, v39, s[60:61]
    s_nop 1
    v_add_f32_dpp v40, v40, v40 quad_perm:[1,0,3,2] row_mask:0xf bank_mask:0xf
    s_nop 1
    v_add_f32_dpp v40, v40, v40 quad_perm:[2,3,0,1] row_mask:0xf bank_mask:0xf
    s_waitcnt vmcnt(6)
    buffer_load_dwordx4 v[136:139], v2, s[8:11], s40 offen offset:512 nt
    v_cvt_pk_bf16_f32 v40, v40, v40
    v_and_b32 v40, s7, v40
    s_waitcnt vmcnt(6)
    buffer_load_dwordx4 v[140:143], v2, s[8:11], s40 offen offset:768 nt
    s_add_u32 s50, s50, 1
    s_and_b32 s53, s50, 63
    s_and_b32 s41, s53, 1
    s_lshl_b32 s41, s41, 12
    s_xor_b32 s40, s49, s41
    s_and_b32 s41, s53, 2
    s_lshl_b32 s41, s41, 16
    s_xor_b32 s40, s40, s41
    s_and_b32 s41, s53, 4
    s_lshl_b32 s41, s41, 14
    s_xor_b32 s40, s40, s41
    s_and_b32 s41, s53, 24
    s_lshl_b32 s41, s41, 15
    s_xor_b32 s40, s40, s41
    s_and_b32 s41, s53, 16
    s_lshl_b32 s41, s41, 10
    s_xor_b32 s40, s40, s41
    s_and_b32 s41, s53, 32
    s_lshl_b32 s41, s41, 9
    s_xor_b32 s40, s40, s41
    v_mul_f32 v40, s42, v40
    v_cvt_pk_bf16_f32 v48, v40, v40
    s_mov_b64 exec, s[54:55]
    ds_write_b16 v26, v48 offset:0
    s_mov_b64 exec, -1
    v_mfma_f32_16x16x32_bf16 v[36:39], v[144:147], v[16:19], 0
    v_mfma_f32_16x16x32_bf16 v[36:39], v[148:151], v[20:23], v[36:39]
    v_mfma_f32_16x16x32_bf16 v[36:39], v[152:155], v[32:35], v[36:39]
    v_mfma_f32_16x16x32_bf16 v[36:39], v[156:159], v[60:63], v[36:39]
    s_waitcnt vmcnt(6)
    buffer_load_dwordx4 v[144:147], v2, s[8:11], s40 offen offset:0 nt
    s_nop 5
    v_cndmask_b32 v40, v36, v37, s[56:57]
    v_cndmask_b32 v40, v40, v38, s[58:59]
    s_waitcnt vmcnt(6)
    buffer_load_dwordx4 v[148:151], v2, s[8:11], s40 offen offset:256 nt
    v_cndmask_b32 v40, v40, v39, s[60:61]
    s_nop 1
    v_add_f32_dpp v40, v40, v40 quad_perm:[1,0,3,2] row_mask:0xf bank_mask:0xf
    s_nop 1
    v_add_f32_dpp v40, v40, v40 quad_perm:[2,3,0,1] row_mask:0xf bank_mask:0xf
    s_waitcnt vmcnt(6)
    buffer_load_dwordx4 v[152:155], v2, s[8:11], s40 offen offset:512 nt
    v_cvt_pk_bf16_f32 v40, v40, v40
    v_and_b32 v40, s7, v40
    s_waitcnt vmcnt(6)
    buffer_load_dwordx4 v[156:159], v2, s[8:11], s40 offen offset:768 nt
    s_add_u32 s50, s50, 1
    s_and_b32 s53, s50, 63
    s_and_b32 s41, s53, 1
    s_lshl_b32 s41, s41, 12
    s_xor_b32 s40, s49, s41
    s_and_b32 s41, s53, 2
    s_lshl_b32 s41, s41, 16
    s_xor_b32 s40, s40, s41
    s_and_b32 s41, s53, 4
    s_lshl_b32 s41, s41, 14
    s_xor_b32 s40, s40, s41
    s_and_b32 s41, s53, 24
    s_lshl_b32 s41, s41, 15
    s_xor_b32 s40, s40, s41
    s_and_b32 s41, s53, 16
    s_lshl_b32 s41, s41, 10
    s_xor_b32 s40, s40, s41
    s_and_b32 s41, s53, 32
    s_lshl_b32 s41, s41, 9
    s_xor_b32 s40, s40, s41
    v_mul_f32 v40, s42, v40
    v_cvt_pk_bf16_f32 v49, v40, v40
    s_mov_b64 exec, s[54:55]
    ds_write_b16 v26, v49 offset:32
    s_mov_b64 exec, -1
    v_add_u32 v26, 64, v26
    s_sub_u32 s44, s44, 1
    s_cmp_eq_u32 s44, 0
    s_cbranch_scc1 L_k_end
    s_waitcnt lgkmcnt(2)
    v_readfirstlane_b32 s43, v31
    v_readfirstlane_b32 s45, v30
    s_nop 0
    s_sub_i32 s45, s45, s51
    s_add_u32 s51, s51, 8
    s_cmp_ge_i32 s45, 3
    s_addc_u32 s43, s43, 0
    s_cmp_le_i32 s45, 0
    s_subb_u32 s43, s43, 0
    s_cmp_eq_u32 s43, 0
    s_cbranch_scc1 L_k0
    s_cmp_eq_u32 s43, 1
    s_cbranch_scc1 L_k1
    s_cmp_eq_u32 s43, 2
    s_cbranch_scc1 L_k2
    s_cmp_eq_u32 s43, 3
    s_cbranch_scc1 L_k3
    s_cmp_eq_u32 s43, 4
    s_cbranch_scc1 L_k4
    s_cmp_eq_u32 s43, 5
    s_cbranch_scc1 L_k5
    s_branch L_k6
L_k6:
    s_mov_b64 exec, 1
    ds_add_u32 v70, v71 offset:2496
    s_mov_b64 exec, -1
    v_mfma_f32_16x16x32_bf16 v[36:39], v[96:99], v[16:19], 0
    v_mfma_f32_16x16x32_bf16 v[36:39], v[100:103], v[20:23], v[36:39]
    v_mfma_f32_16x16x32_bf16 v[36:39], v[104:107], v[32:35], v[36:39]
    v_mfma_f32_16x16x32_bf16 v[36:39], v[108:111], v[60:63], v[36:39]
    buffer_load_dwordx4 v[96:99], v2, s[8:11], s40 offen offset:0 nt
    s_nop 6
    v_cndmask_b32 v40, v36, v37, s[56:57]
    v_cndmask_b32 v40, v40, v38, s[58:59]
    s_waitcnt vmcnt(7)
    buffer_load_dwordx4 v[100:103], v2, s[8:11], s40 offen offset:256 nt
    v_cndmask_b32 v40, v40, v39, s[60:61]
    s_nop 1
    v_add_f32_dpp v40, v40, v40 quad_perm:[1,0,3,2] row_mask:0xf bank_mask:0xf
    s_nop 1
    v_add_f32_dpp v40, v40, v40 quad_perm:[2,3,0,1] row_mask:0xf bank_mask:0xf
    s_waitcnt vmcnt(7)
    buffer_load_dwordx4 v[104:107], v2, s[8:11], s40 offen offset:512 nt
    v_cvt_pk_bf16_f32 v40, v40, v40
    v_and_b32 v40, s7, v40
    s_waitcnt vmcnt(7)
    buffer_load_dwordx4 v[108:111], v2, s[8:11], s40 offen offset:768 nt
    s_add_u32 s50, s50, 1
    s_and_b32 s53, s50, 63
    s_and_b32 s41, s53, 1
    s_lshl_b32 s41, s41, 12
    s_xor_b32 s40, s49, s41
    s_and_b32 s41, s53, 2
    s_lshl_b32 s41, s41, 16
    s_xor_b32 s40, s40, s41
    s_and_b32 s41, s53, 4
    s_lshl_b32 s41, s41, 14
    s_xor_b32 s40, s40, s41
    s_and_b32 s41, s53, 24
    s_lshl_b32 s41, s41, 15
    s_xor_b32 s40, s40, s41
    s_and_b32 s41, s53, 16
    s_lshl_b32 s41, s41, 10
    s_xor_b32 s40, s40, s41
    s_and_b32 s41, s53, 32
    s_lshl_b32 s41, s41, 9
    s_xor_b32 s40, s40, s41
    v_mul_f32 v40, s42, v40
    v_cvt_pk_bf16_f32 v48, v40, v40
    s_mov_b64 exec, s[54:55]
    ds_write_b16 v26, v48 offset:0
    s_mov_b64 exec, -1
    v_mfma_f32_16x16x32_bf16 v[36:39], v[112:115], v[16:19], 0
    v_mfma_f32_16x16x32_bf16 v[36:39], v[116:119], v[20:23], v[36:39]
    v_mfma_f32_16x16x32_bf16 v[36:39], v[120:123], v[32:35], v[36:39]
    v_mfma_f32_16x16x32_bf16 v[36:39], v[124:127], v[60:63], v[36:39]
    s_waitcnt vmcnt(7)
    buffer_load_dwordx4 v[112:115], v2, s[8:11], s40 offen offset:0 nt
    s_nop 5
    v_cndmask_b32 v40, v36, v37, s[56:57]
    v_cndmask_b32 v40, v40, v38, s[58:59]
    s_waitcnt vmcnt(7)
    buffer_load_dwordx4 v[116:119], v2, s[8:11], s40 offen offset:256 nt
    v_cndmask_b32 v40, v40, v39, s[60:61]
    s_nop 1
    v_add_f32_dpp v40, v40, v40 quad_perm:[1,0,3,2] row_mask:0xf bank_mask:0xf
    s_nop 1
    v_add_f32_dpp v40, v40, v40 quad_perm:[2,3,0,1] row_mask:0xf bank_mask:0xf
    s_waitcnt vmcnt(7)
    buffer_load_dwordx4 v[120:123], v2, s[8:11], s40 offen offset:512 nt
    v_cvt_pk_bf16_f32 v40, v40, v40
    v_and_b32 v40, s7, v40
    s_waitcnt vmcnt(7)
    buffer_load_dwordx4 v[124:127], v2, s[8:11], s40 offen offset:768 nt
    s_add_u32 s50, s50, 1
    s_and_b32 s53, s50, 63
    s_and_b32 s41, s53, 1
    s_lshl_b32 s41, s41, 12
    s_xor_b32 s40, s49, s41
    s_and_b32 s41, s53, 2
    s_lshl_b32 s41, s41, 16
    s_xor_b32 s40, s40, s41
    s_and_b32 s41, s53, 4
    s_lshl_b32 s41, s41, 14
    s_xor_b32 s40, s40, s41
    s_and_b32 s41, s53, 24
    s_lshl_b32 s41, s41, 15
    s_xor_b32 s40, s40, s41
    s_and_b32 s41, s53, 16
    s_lshl_b32 s41, s41, 10
    s_xor_b32 s40, s40, s41
    s_and_b32 s41, s53, 32
    s_lshl_b32 s41, s41, 9
    s_xor_b32 s40, s40, s41
    v_mul_f32 v40, s42, v40
    v_cvt_pk_bf16_f32 v49, v40, v40
    s_mov_b64 exec, s[54:55]
    ds_write_b16 v26, v49 offset:32
    s_mov_b64 exec, -1
    v_add_u32 v26, 64, v26
    s_mov_b64 exec, 1
    ds_add_rtn_u32 v30, v70, v71 offset:2496
    s_mov_b64 exec, -1
    ds_read_b32 v31, v70 offset:2500
    v_mfma_f32_16x16x32_bf16 v[36:39], v[128:131], v[16:19], 0
    v_mfma_f32_16x16x32_bf16 v[36:39], v[132:135], v[20:23], v[36:39]
    v_mfma_f32_16x16x32_bf16 v[36:39], v[136:139], v[32:35], v[36:39]
    v_mfma_f32_16x16x32_bf16 v[36:39], v[140:143], v[60:63], v[36:39]
    s_waitcnt vmcnt(7)
    buffer_load_dwordx4 v[128:131], v2, s[8:11], s40 offen offset:0 nt
    s_nop 5
    v_cndmask_b32 v40, v36, v37, s[56:57]
    v_cndmask_b32 v40, v40, v38, s[58:59]
    s_waitcnt vmcnt(7)
    buffer_load_dwordx4 v[132:135], v2, s[8:11], s40 offen offset:256 nt
    v_cndmask_b32 v40, v40, v39, s[60:61]
    s_nop 1
    v_add_f32_dpp v40, v40, v40 quad_perm:[1,0,3,2] row_mask:0xf bank_mask:0xf
    s_nop 1
    v_add_f32_dpp v40, v40, v40 quad_perm:[2,3,0,1] row_mask:0xf bank_mask:0xf
    s_waitcnt vmcnt(7)
    buffer_load_dwordx4 v[136:139], v2, s[8:11], s40 offen offset:512 nt
    v_cvt_pk_bf16_f32 v40, v40, v40
    v_and_b32 v40, s7, v40
    s_waitcnt vmcnt(7)
    buffer_load_dwordx4 v[140:143], v2, s[8:11], s40 offen offset:768 nt
    s_add_u32 s50, s50, 1
    s_and_b32 s53, s50, 63
    s_and_b32 s41, s53, 1
    s_lshl_b32 s41, s41, 12
    s_xor_b32 s40, s49, s41
    s_and_b32 s41, s53, 2
    s_lshl_b32 s41, s41, 16
    s_xor_b32 s40, s40, s41
    s_and_b32 s41, s53, 4
    s_lshl_b32 s41, s41, 14
    s_xor_b32 s40, s40, s41
    s_and_b32 s41, s53, 24
    s_lshl_b32 s41, s41, 15
    s_xor_b32 s40, s40, s41
    s_and_b32 s41, s53, 16
    s_lshl_b32 s41, s41, 10
    s_xor_b32 s40, s40, s41
    s_and_b32 s41, s53, 32
    s_lshl_b32 s41, s41, 9
    s_xor_b32 s40, s40, s41
    v_mul_f32 v40, s42, v40
    v_cvt_pk_bf16_f32 v48, v40, v40
    s_mov_b64 exec, s[54:55]
    ds_write_b16 v26, v48 offset:0
    s_mov_b64 exec, -1
    v_mfma_f32_16x16x32_bf16 v[36:39], v[144:147], v[16:19], 0
    v_mfma_f32_16x16x32_bf16 v[36:39], v[148:151], v[20:23], v[36:39]
    v_mfma_f32_16x16x32_bf16 v[36:39], v[152:155], v[32:35], v[36:39]
    v_mfma_f32_16x16x32_bf16 v[36:39], v[156:159], v[60:63], v[36:39]
    s_waitcnt vmcnt(7)
    buffer_load_dwordx4 v[144:147], v2, s[8:11], s40 offen offset:0 nt
    s_nop 5
    v_cndmask_b32 v40, v36, v37, s[56:57]
    v_cndmask_b32 v40, v40, v38, s[58:59]
    s_waitcnt vmcnt(7)
    buffer_load_dwordx4 v[148:151], v2, s[8:11], s40 offen offset:256 nt
    v_cndmask_b32 v40, v40, v39, s[60:61]
    s_nop 1
    v_add_f32_dpp v40, v40, v40 quad_perm:[1,0,3,2] row_mask:0xf bank_mask:0xf
    s_nop 1
    v_add_f32_dpp v40, v40, v40 quad_perm:[2,3,0,1] row_mask:0xf bank_mask:0xf
    s_waitcnt vmcnt(7)
    buffer_load_dwordx4 v[152:155], v2, s[8:11], s40 offen offset:512 nt
    v_cvt_pk_bf16_f32 v40, v40, v40
    v_and_b32 v40, s7, v40
    s_waitcnt vmcnt(7)
    buffer_load_dwordx4 v[156:159], v2, s[8:11], s40 offen offset:768 nt
    s_add_u32 s50, s50, 1
    s_and_b32 s53, s50, 63
    s_and_b32 s41, s53, 1
    s_lshl_b32 s41, s41, 12
    s_xor_b32 s40, s49, s41
    s_and_b32 s41, s53, 2
    s_lshl_b32 s41, s41, 16
    s_xor_b32 s40, s40, s41
    s_and_b32 s41, s53, 4
    s_lshl_b32 s41, s41, 14
    s_xor_b32 s40, s40, s41
    s_and_b32 s41, s53, 24
    s_lshl_b32 s41, s41, 15
    s_xor_b32 s40, s40, s41
    s_and_b32 s41, s53, 16
    s_lshl_b32 s41, s41, 10
    s_xor_b32 s40, s40, s41
    s_and_b32 s41, s53, 32
    s_lshl_b32 s41, s41, 9
    s_xor_b32 s40, s40, s41
    v_mul_f32 v40, s42, v40
    v_cvt_pk_bf16_f32 v49, v40, v40
    s_mov_b64 exec, s[54:55]
    ds_write_b16 v26, v49 offset:32
    s_mov_b64 exec, -1
    v_add_u32 v26, 64, v26
    s_sub_u32 s44, s44, 1
    s_cmp_eq_u32 s44, 0
    s_cbranch_scc1 L_k_end
    s_waitcnt lgkmcnt(2)
    v_readfirstlane_b32 s43, v31
    v_readfirstlane_b32 s45, v30
    s_nop 0
    s_sub_i32 s45, s45, s51
    s_add_u32 s51, s51, 8
    s_cmp_ge_i32 s45, 3
    s_addc_u32 s43, s43, 0
    s_cmp_le_i32 s45, 0
    s_subb_u32 s43, s43, 0
    s_cmp_eq_u32 s43, 0
    s_cbranch_scc1 L_k0
    s_cmp_eq_u32 s43, 1
    s_cbranch_scc1 L_k1
    s_cmp_eq_u32 s43, 2
    s_cbranch_scc1 L_k2
    s_cmp_eq_u32 s43, 3
    s_cbranch_scc1 L_k3
    s_cmp_eq_u32 s43, 4
    s_cbranch_scc1 L_k4
    s_cmp_eq_u32 s43, 5
    s_cbranch_scc1 L_k5
    s_branch L_k6
L_k_end:
    s_mov_b64 exec, 1
    ds_add_u32 v70, v71 offset:2496
    s_mov_b64 exec, -1
    v_mfma_f32_16x16x32_bf16 v[36:39], v[96:99], v[16:19], 0
    v_mfma_f32_16x16x32_bf16 v[36:39], v[100:103], v[20:23], v[36:39]
    v_mfma_f32_16x16x32_bf16 v[36:39], v[104:107], v[32:35], v[36:39]
    v_mfma_f32_16x16x32_bf16 v[36:39], v[108:111], v[60:63], v[36:39]
    s_waitcnt vmcnt(5)
    buffer_load_dwordx4 v[96:99], v2, s[8:11], s40 offen offset:0 nt
    s_nop 5
    v_cndmask_b32 v40, v36, v37, s[56:57]
    v_cndmask_b32 v40, v40, v38, s[58:59]
    s_waitcnt vmcnt(5)
    buffer_load_dwordx4 v[100:103], v2, s[8:11], s40 offen offset:256 nt
    v_cndmask_b32 v40, v40, v39, s[60:61]
    s_nop 1
    v_add_f32_dpp v40, v40, v40 quad_perm:[1,0,3,2] row_mask:0xf bank_mask:0xf
    s_nop 1
    v_add_f32_dpp v40, v40, v40 quad_perm:[2,3,0,1] row_mask:0xf bank_mask:0xf
    s_waitcnt vmcnt(5)
    buffer_load_dwordx4 v[104:107], v2, s[8:11], s40 offen offset:512 nt
    v_cvt_pk_bf16_f32 v40, v40, v40
    v_and_b32 v40, s7, v40
    s_waitcnt vmcnt(5)
    buffer_load_dwordx4 v[108:111], v2, s[8:11], s40 offen offset:768 nt
    s_add_u32 s50, s50, 1
    s_and_b32 s53, s50, 63
    s_and_b32 s41, s53, 1
    s_lshl_b32 s41, s41, 12
    s_xor_b32 s40, s49, s41
    s_and_b32 s41, s53, 2
    s_lshl_b32 s41, s41, 16
    s_xor_b32 s40, s40, s41
    s_and_b32 s41, s53, 4
    s_lshl_b32 s41, s41, 14
    s_xor_b32 s40, s40, s41
    s_and_b32 s41, s53, 24
    s_lshl_b32 s41, s41, 15
    s_xor_b32 s40, s40, s41
    s_and_b32 s41, s53, 16
    s_lshl_b32 s41, s41, 10
    s_xor_b32 s40, s40, s41
    s_and_b32 s41, s53, 32
    s_lshl_b32 s41, s41, 9
    s_xor_b32 s40, s40, s41
    v_mul_f32 v40, s42, v40
    v_cvt_pk_bf16_f32 v48, v40, v40
    s_mov_b64 exec, s[54:55]
    ds_write_b16 v26, v48 offset:0
    s_mov_b64 exec, -1
    v_mfma_f32_16x16x32_bf16 v[36:39], v[112:115], v[16:19], 0
    v_mfma_f32_16x16x32_bf16 v[36:39], v[116:119], v[20:23], v[36:39]
    v_mfma_f32_16x16x32_bf16 v[36:39], v[120:123], v[32:35], v[36:39]
    v_mfma_f32_16x16x32_bf16 v[36:39], v[124:127], v[60:63], v[36:39]
    s_waitcnt vmcnt(5)
    buffer_load_dwordx4 v[112:115], v2, s[8:11], s40 offen offset:0 nt
    s_nop 5
    v_cndmask_b32 v40, v36, v37, s[56:57]
    v_cndmask_b32 v40, v40, v38, s[58:59]
    s_waitcnt vmcnt(5)
    buffer_load_dwordx4 v[116:119], v2, s[8:11], s40 offen offset:256 nt
    v_cndmask_b32 v40, v40, v39, s[60:61]
    s_nop 1
    v_add_f32_dpp v40, v40, v40 quad_perm:[1,0,3,2] row_mask:0xf bank_mask:0xf
    s_nop 1
    v_add_f32_dpp v40, v40, v40 quad_perm:[2,3,0,1] row_mask:0xf bank_mask:0xf
    s_waitcnt vmcnt(5)
    buffer_load_dwordx4 v[120:123], v2, s[8:11], s40 offen offset:512 nt
    v_cvt_pk_bf16_f32 v40, v40, v40
    v_and_b32 v40, s7, v40
    s_waitcnt vmcnt(5)
    buffer_load_dwordx4 v[124:127], v2, s[8:11], s40 offen offset:768 nt
    s_add_u32 s50, s50, 1
    s_and_b32 s53, s50, 63
    s_and_b32 s41, s53, 1
    s_lshl_b32 s41, s41, 12
    s_xor_b32 s40, s49, s41
    s_and_b32 s41, s53, 2
    s_lshl_b32 s41, s41, 16
    s_xor_b32 s40, s40, s41
    s_and_b32 s41, s53, 4
    s_lshl_b32 s41, s41, 14
    s_xor_b32 s40, s40, s41
    s_and_b32 s41, s53, 24
    s_lshl_b32 s41, s41, 15
    s_xor_b32 s40, s40, s41
    s_and_b32 s41, s53, 16
    s_lshl_b32 s41, s41, 10
    s_xor_b32 s40, s40, s41
    s_and_b32 s41, s53, 32
    s_lshl_b32 s41, s41, 9
    s_xor_b32 s40, s40, s41
    v_mul_f32 v40, s42, v40
    v_cvt_pk_bf16_f32 v49, v40, v40
    s_mov_b64 exec, s[54:55]
    ds_write_b16 v26, v49 offset:32
    s_mov_b64 exec, -1
    v_add_u32 v26, 64, v26
    s_mov_b64 exec, 1
    ds_add_u32 v70, v71 offset:2496
    s_mov_b64 exec, -1
    v_mfma_f32_16x16x32_bf16 v[36:39], v[128:131], v[16:19], 0
    v_mfma_f32_16x16x32_bf16 v[36:39], v[132:135], v[20:23], v[36:39]
    v_mfma_f32_16x16x32_bf16 v[36:39], v[136:139], v[32:35], v[36:39]
    v_mfma_f32_16x16x32_bf16 v[36:39], v[140:143], v[60:63], v[36:39]
    s_waitcnt vmcnt(5)
    buffer_load_dwordx4 v[128:131], v3, s[12:15], s40 offen offset:0 nt
    s_nop 5
    v_cndmask_b32 v40, v36, v37, s[56:57]
    v_cndmask_b32 v40, v40, v38, s[58:59]
    s_waitcnt vmcnt(5)
    buffer_load_dwordx4 v[132:135], v3, s[12:15], s40 offen offset:256 nt
    v_cndmask_b32 v40, v40, v39, s[60:61]
    s_nop 1
    v_add_f32_dpp v40, v40, v40 quad_perm:[1,0,3,2] row_mask:0xf bank_mask:0xf
    s_nop 1
    v_add_f32_dpp v40, v40, v40 quad_perm:[2,3,0,1] row_mask:0xf bank_mask:0xf
    s_waitcnt vmcnt(5)
    buffer_load_dwordx4 v[136:139], v3, s[12:15], s40 offen offset:512 nt
    v_cvt_pk_bf16_f32 v40, v40, v40
    v_and_b32 v40, s7, v40
    s_waitcnt vmcnt(5)
    buffer_load_dwordx4 v[140:143], v3, s[12:15], s40 offen offset:768 nt
    s_add_u32 s50, s50, 1
    s_and_b32 s53, s50, 63
    s_and_b32 s41, s53, 1
    s_lshl_b32 s41, s41, 12
    s_xor_b32 s40, s49, s41
    s_and_b32 s41, s53, 2
    s_lshl_b32 s41, s41, 16
    s_xor_b32 s40, s40, s41
    s_and_b32 s41, s53, 4
    s_lshl_b32 s41, s41, 14
    s_xor_b32 s40, s40, s41
    s_and_b32 s41, s53, 24
    s_lshl_b32 s41, s41, 15
    s_xor_b32 s40, s40, s41
    s_and_b32 s41, s53, 16
    s_lshl_b32 s41, s41, 10
    s_xor_b32 s40, s40, s41
    s_and_b32 s41, s53, 32
    s_lshl_b32 s41, s41, 9
    s_xor_b32 s40, s40, s41
    v_mul_f32 v40, s42, v40
    v_cvt_pk_bf16_f32 v48, v40, v40
    s_mov_b64 exec, s[54:55]
    ds_write_b16 v26, v48 offset:0
    s_mov_b64 exec, -1
    v_mfma_f32_16x16x32_bf16 v[36:39], v[144:147], v[16:19], 0
    v_mfma_f32_16x16x32_bf16 v[36:39], v[148:151], v[20:23], v[36:39]
    v_mfma_f32_16x16x32_bf16 v[36:39], v[152:155], v[32:35], v[36:39]
    v_mfma_f32_16x16x32_bf16 v[36:39], v[156:159], v[60:63], v[36:39]
    s_waitcnt vmcnt(5)
    buffer_load_dwordx4 v[144:147], v3, s[12:15], s40 offen offset:0 nt
    s_nop 5
    v_cndmask_b32 v40, v36, v37, s[56:57]
    v_cndmask_b32 v40, v40, v38, s[58:59]
    s_waitcnt vmcnt(5)
    buffer_load_dwordx4 v[148:151], v3, s[12:15], s40 offen offset:256 nt
    v_cndmask_b32 v40, v40, v39, s[60:61]
    s_nop 1
    v_add_f32_dpp v40, v40, v40 quad_perm:[1,0,3,2] row_mask:0xf bank_mask:0xf
    s_nop 1
    v_add_f32_dpp v40, v40, v40 quad_perm:[2,3,0,1] row_mask:0xf bank_mask:0xf
    s_waitcnt vmcnt(5)
    buffer_load_dwordx4 v[152:155], v3, s[12:15], s40 offen offset:512 nt
    v_cvt_pk_bf16_f32 v40, v40, v40
    v_and_b32 v40, s7, v40
    s_waitcnt vmcnt(5)
    buffer_load_dwordx4 v[156:159], v3, s[12:15], s40 offen offset:768 nt
    s_add_u32 s50, s50, 1
    s_and_b32 s53, s50, 63
    s_and_b32 s41, s53, 1
    s_lshl_b32 s41, s41, 12
    s_xor_b32 s40, s49, s41
    s_and_b32 s41, s53, 2
    s_lshl_b32 s41, s41, 16
    s_xor_b32 s40, s40, s41
    s_and_b32 s41, s53, 4
    s_lshl_b32 s41, s41, 14
    s_xor_b32 s40, s40, s41
    s_and_b32 s41, s53, 24
    s_lshl_b32 s41, s41, 15
    s_xor_b32 s40, s40, s41
    s_and_b32 s41, s53, 16
    s_lshl_b32 s41, s41, 10
    s_xor_b32 s40, s40, s41
    s_and_b32 s41, s53, 32
    s_lshl_b32 s41, s41, 9
    s_xor_b32 s40, s40, s41
    v_mul_f32 v40, s42, v40
    v_cvt_pk_bf16_f32 v49, v40, v40
    s_mov_b64 exec, s[54:55]
    ds_write_b16 v26, v49 offset:32
    s_mov_b64 exec, -1
    v_add_u32 v26, 64, v26
    s_mov_b64 exec, 1
    ds_add_u32 v70, v71 offset:2496
    s_mov_b64 exec, -1
    v_mfma_f32_16x16x32_bf16 v[36:39], v[96:99], v[16:19], 0
    v_mfma_f32_16x16x32_bf16 v[36:39], v[100:103], v[20:23], v[36:39]
    v_mfma_f32_16x16x32_bf16 v[36:39], v[104:107], v[32:35], v[36:39]
    v_mfma_f32_16x16x32_bf16 v[36:39], v[108:111], v[60:63], v[36:39]
    s_waitcnt vmcnt(5)
    buffer_load_dwordx4 v[96:99], v3, s[12:15], s40 offen offset:0 nt
    s_nop 5
    v_cndmask_b32 v40, v36, v37, s[56:57]
    v_cndmask_b32 v40, v40, v38, s[58:59]
    s_waitcnt vmcnt(5)
    buffer_load_dwordx4 v[100:103], v3, s[12:15], s40 offen offset:256 nt
    v_cndmask_b32 v40, v40, v39, s[60:61]
    s_nop 1
    v_add_f32_dpp v40, v40, v40 quad_perm:[1,0,3,2] row_mask:0xf bank_mask:0xf
    s_nop 1
    v_add_f32_dpp v40, v40, v40 quad_perm:[2,3,0,1] row_mask:0xf bank_mask:0xf
    s_waitcnt vmcnt(5)
    buffer_load_dwordx4 v[104:107], v3, s[12:15], s40 offen offset:512 nt
    v_cvt_pk_bf16_f32 v40, v40, v40
    v_and_b32 v40, s7, v40
    s_waitcnt vmcnt(5)
    buffer_load_dwordx4 v[108:111], v3, s[12:15], s40 offen offset:768 nt
    s_add_u32 s50, s50, 1
    s_and_b32 s53, s50, 63
    s_and_b32 s41, s53, 1
    s_lshl_b32 s41, s41, 12
    s_xor_b32 s40, s49, s41
    s_and_b32 s41, s53, 2
    s_lshl_b32 s41, s41, 16
    s_xor_b32 s40, s40, s41
    s_and_b32 s41, s53, 4
    s_lshl_b32 s41, s41, 14
    s_xor_b32 s40, s40, s41
    s_and_b32 s41, s53, 24
    s_lshl_b32 s41, s41, 15
    s_xor_b32 s40, s40, s41
    s_and_b32 s41, s53, 16
    s_lshl_b32 s41, s41, 10
    s_xor_b32 s40, s40, s41
    s_and_b32 s41, s53, 32
    s_lshl_b32 s41, s41, 9
    s_xor_b32 s40, s40, s41
    v_mul_f32 v40, s42, v40
    v_cvt_pk_bf16_f32 v48, v40, v40
    s_mov_b64 exec, s[54:55]
    ds_write_b16 v26, v48 offset:0
    s_mov_b64 exec, -1
    v_mfma_f32_16x16x32_bf16 v[36:39], v[112:115], v[16:19], 0
    v_mfma_f32_16x16x32_bf16 v[36:39], v[116:119], v[20:23], v[36:39]
    v_mfma_f32_16x16x32_bf16 v[36:39], v[120:123], v[32:35], v[36:39]
    v_mfma_f32_16x16x32_bf16 v[36:39], v[124:127], v[60:63], v[36:39]
    s_waitcnt vmcnt(5)
    buffer_load_dwordx4 v[112:115], v3, s[12:15], s40 offen offset:0 nt
    s_nop 5
    v_cndmask_b32 v40, v36, v37, s[56:57]
    v_cndmask_b32 v40, v40, v38, s[58:59]
    s_waitcnt vmcnt(5)
    buffer_load_dwordx4 v[116:119], v3, s[12:15], s40 offen offset:256 nt
    v_cndmask_b32 v40, v40, v39, s[60:61]
    s_nop 1
    v_add_f32_dpp v40, v40, v40 quad_perm:[1,0,3,2] row_mask:0xf bank_mask:0xf
    s_nop 1
    v_add_f32_dpp v40, v40, v40 quad_perm:[2,3,0,1] row_mask:0xf bank_mask:0xf
    s_waitcnt vmcnt(5)
    buffer_load_dwordx4 v[120:123], v3, s[12:15], s40 offen offset:512 nt
    v_cvt_pk_bf16_f32 v40, v40, v40
    v_and_b32 v40, s7, v40
    s_waitcnt vmcnt(5)
    buffer_load_dwordx4 v[124:127], v3, s[12:15], s40 offen offset:768 nt
    s_add_u32 s50, s50, 1
    s_and_b32 s53, s50, 63
    s_and_b32 s41, s53, 1
    s_lshl_b32 s41, s41, 12
    s_xor_b32 s40, s49, s41
    s_and_b32 s41, s53, 2
    s_lshl_b32 s41, s41, 16
    s_xor_b32 s40, s40, s41
    s_and_b32 s41, s53, 4
    s_lshl_b32 s41, s41, 14
    s_xor_b32 s40, s40, s41
    s_and_b32 s41, s53, 24
    s_lshl_b32 s41, s41, 15
    s_xor_b32 s40, s40, s41
    s_and_b32 s41, s53, 16
    s_lshl_b32 s41, s41, 10
    s_xor_b32 s40, s40, s41
    s_and_b32 s41, s53, 32
    s_lshl_b32 s41, s41, 9
    s_xor_b32 s40, s40, s41
    v_mul_f32 v40, s42, v40
    v_cvt_pk_bf16_f32 v49, v40, v40
    s_mov_b64 exec, s[54:55]
    ds_write_b16 v26, v49 offset:32
    s_mov_b64 exec, -1
    v_add_u32 v26, 64, v26
    s_waitcnt vmcnt(5)
    buffer_load_dwordx4 v[160:163], v3, s[12:15], s40 offen offset:0 nt
    s_waitcnt lgkmcnt(0)
    ds_read_b128 v[80:83], v27
    ds_read_b128 v[84:87], v27 offset:16
    s_waitcnt lgkmcnt(0)
    v_lshlrev_b32 v40, 16, v80
    v_and_b32 v41, s7, v80
    v_lshlrev_b32 v42, 16, v81
    v_and_b32 v43, s7, v81
    v_lshlrev_b32 v44, 16, v82
    v_and_b32 v45, s7, v82
    v_lshlrev_b32 v46, 16, v83
    v_and_b32 v47, s7, v83
    v_lshlrev_b32 v48, 16, v84
    v_and_b32 v49, s7, v84
    v_lshlrev_b32 v50, 16, v85
    v_and_b32 v51, s7, v85
    v_lshlrev_b32 v52, 16, v86
    v_and_b32 v53, s7, v86
    v_lshlrev_b32 v54, 16, v87
    s_waitcnt vmcnt(5)
    buffer_load_dwordx4 v[164:167], v3, s[12:15], s40 offen offset:256 nt
    v_and_b32 v55, s7, v87
    v_max3_f32 v36, v40, v41, v42
    v_max3_f32 v37, v43, v44, v45
    v_max3_f32 v38, v46, v47, v48
    v_max3_f32 v39, v49, v50, v51
    v_max3_f32 v36, v36, v52, v53
    v_max3_f32 v37, v37, v54, v55
    v_max3_f32 v36, v36, v37, v38
    v_max_f32 v36, v36, v39
    s_nop 1
    v_max_f32_dpp v36, v36, v36 quad_perm:[1,0,3,2] row_mask:0xf bank_mask:0xf
    s_nop 1
    v_max_f32_dpp v36, v36, v36 quad_perm:[2,3,0,1] row_mask:0xf bank_mask:0xf
    s_nop 1
    v_max_f32_dpp v36, v36, v36 row_half_mirror row_mask:0xf bank_mask:0xf
    s_nop 1
    v_max_f32_dpp v36, v36, v36 row_mirror row_mask:0xf bank_mask:0xf
    v_mov_b32 v39, v36
    s_nop 1
    v_permlane16_swap_b32 v36, v39
    v_max_f32 v36, v36, v39
    v_mov_b32 v39, v36
    s_nop 1
    v_permlane32_swap_b32 v36, v39
    v_max_f32 v36, v36, v39
    s_waitcnt vmcnt(5)
    buffer_load_dwordx4 v[168:171], v3, s[12:15], s40 offen offset:512 nt
    v_mul_f32 v38, s6, v36
    v_fma_f32 v40, v40, s6, -v38
    v_fma_f32 v41, v41, s6, -v38
    v_fma_f32 v42, v42, s6, -v38
    v_fma_f32 v43, v43, s6, -v38
    v_fma_f32 v44, v44, s6, -v38
    v_fma_f32 v45, v45, s6, -v38
    v_fma_f32 v46, v46, s6, -v38
    v_fma_f32 v47, v47, s6, -v38
    v_fma_f32 v48, v48, s6, -v38
    v_fma_f32 v49, v49, s6, -v38
    v_fma_f32 v50, v50, s6, -v38
    v_fma_f32 v51, v51, s6, -v38
    v_fma_f32 v52, v52, s6, -v38
    v_fma_f32 v53, v53, s6, -v38
    v_fma_f32 v54, v54, s6, -v38
    v_fma_f32 v55, v55, s6, -v38
    v_exp_f32 v40, v40
    v_exp_f32 v41, v41
    v_exp_f32 v42, v42
    s_waitcnt vmcnt(5)
    buffer_load_dwordx4 v[172:175], v3, s[12:15], s40 offen offset:768 nt
    s_add_u32 s50, s50, 1
    s_and_b32 s53, s50, 63
    s_and_b32 s41, s53, 1
    s_lshl_b32 s41, s41, 12
    s_xor_b32 s40, s49, s41
    s_and_b32 s41, s53, 2
    s_lshl_b32 s41, s41, 16
    s_xor_b32 s40, s40, s41
    s_and_b32 s41, s53, 4
    s_lshl_b32 s41, s41, 14
    s_xor_b32 s40, s40, s41
    s_and_b32 s41, s53, 24
    s_lshl_b32 s41, s41, 15
    s_xor_b32 s40, s40, s41
    s_and_b32 s41, s53, 16
    s_lshl_b32 s41, s41, 10
    s_xor_b32 s40, s40, s41
    s_and_b32 s41, s53, 32
    s_lshl_b32 s41, s41, 9
    s_xor_b32 s40, s40, s41
    v_exp_f32 v43, v43
    v_exp_f32 v44, v44
    v_exp_f32 v45, v45
    v_exp_f32 v46, v46
    v_exp_f32 v47, v47
    v_exp_f32 v48, v48
    v_exp_f32 v49, v49
    v_exp_f32 v50, v50
    v_exp_f32 v51, v51
    v_exp_f32 v52, v52
    v_exp_f32 v53, v53
    v_exp_f32 v54, v54
    v_exp_f32 v55, v55
    v_add_f32 v80, v40, v41
    v_add_f32 v81, v42, v43
    v_add_f32 v82, v44, v45
    v_add_f32 v83, v46, v47
    v_add_f32 v84, v48, v49
    v_add_f32 v85, v50, v51
    s_waitcnt vmcnt(5)
    buffer_load_dwordx4 v[176:179], v3, s[12:15], s40 offen offset:0 nt
    v_add_f32 v86, v52, v53
    v_add_f32 v87, v54, v55
    v_add_f32 v80, v80, v84
    v_add_f32 v81, v81, v85
    v_add_f32 v82, v82, v86
    v_add_f32 v83, v83, v87
    v_add_f32 v80, v80, v82
    v_add_f32 v81, v81, v83
    v_add_f32 v37, v80, v81
    s_nop 1
    v_add_f32_dpp v37, v37, v37 quad_perm:[1,0,3,2] row_mask:0xf bank_mask:0xf
    s_nop 1
    v_add_f32_dpp v37, v37, v37 quad_perm:[2,3,0,1] row_mask:0xf bank_mask:0xf
    s_nop 1
    v_add_f32_dpp v37, v37, v37 row_half_mirror row_mask:0xf bank_mask:0xf
    s_nop 1
    v_add_f32_dpp v37, v37, v37 row_mirror row_mask:0xf bank_mask:0xf
    v_mov_b32 v39, v37
    s_nop 1
    v_permlane16_swap_b32 v37, v39
    v_add_f32 v37, v37, v39
    v_mov_b32 v39, v37
    s_nop 1
    v_permlane32_swap_b32 v37, v39
    v_add_f32 v37, v37, v39
    s_mov_b64 exec, 1
    ds_write_b64 v29, v[36:37] offset:2304
    ds_write_b32 v29, v71 offset:2312
    s_mov_b64 exec, -1
    s_mov_b32 s44, 262144
L_sm:
    ds_read_b128 v[56:59], v28 offset:2304
    s_waitcnt lgkmcnt(0)
    v_cmp_ne_u32 vcc, 1, v58
    s_cbranch_vccz L_sm_ok
    s_sub_u32 s44, s44, 1
    s_cmp_lg_u32 s44, 0
    s_cbranch_scc1 L_sm
L_sm_ok:
    s_waitcnt vmcnt(5)
    buffer_load_dwordx4 v[180:183], v3, s[12:15], s40 offen offset:256 nt
    v_mov_b32 v58, v56
    s_nop 1
    v_max_f32_dpp v58, v58, v58 quad_perm:[1,0,3,2] row_mask:0xf bank_mask:0xf
    s_nop 1
    v_max_f32_dpp v58, v58, v58 quad_perm:[2,3,0,1] row_mask:0xf bank_mask:0xf
    v_sub_f32 v56, v56, v58
    v_sub_f32 v36, v36, v58
    v_mul_f32 v56, s6, v56
    v_mul_f32 v36, s6, v36
    v_exp_f32 v56, v56
    v_exp_f32 v36, v36
    v_mul_f32 v56, v56, v57
    s_nop 1
    v_add_f32_dpp v56, v56, v56 quad_perm:[1,0,3,2] row_mask:0xf bank_mask:0xf
    s_nop 1
    v_add_f32_dpp v56, v56, v56 quad_perm:[2,3,0,1] row_mask:0xf bank_mask:0xf
    v_rcp_f32 v57, v56
    s_nop 0
    v_fma_f32 v58, -v56, v57, 1.0
    v_fma_f32 v57, v58, v57, v57
    v_mul_f32 v36, v36, v57
    v_mul_f32 v40, v40, v36
    v_mul_f32 v41, v41, v36
    v_mul_f32 v42, v42, v36
    v_mul_f32 v43, v43, v36
    v_mul_f32 v44, v44, v36
    v_mul_f32 v45, v45, v36
    s_waitcnt vmcnt(5)
    buffer_load_dwordx4 v[184:187], v3, s[12:15], s40 offen offset:512 nt
    v_mul_f32 v46, v46, v36
    v_mul_f32 v47, v47, v36
    v_mul_f32 v48, v48, v36
    v_mul_f32 v49, v49, v36
    v_mul_f32 v50, v50, v36
    v_mul_f32 v51, v51, v36
    v_mul_f32 v52, v52, v36
    v_mul_f32 v53, v53, v36
    v_mul_f32 v54, v54, v36
    v_mul_f32 v55, v55, v36
    v_cvt_pk_bf16_f32 v80, v40, v41
    v_cvt_pk_bf16_f32 v81, v42, v43
    v_cvt_pk_bf16_f32 v82, v44, v45
    v_cvt_pk_bf16_f32 v83, v46, v47
    v_cvt_pk_bf16_f32 v84, v48, v49
    v_cvt_pk_bf16_f32 v85, v50, v51
    v_cvt_pk_bf16_f32 v86, v52, v53
    v_cvt_pk_bf16_f32 v87, v54, v55
    ds_write_b128 v27, v[80:83]
    ds_write_b128 v27, v[84:87] offset:16
    v_mov_b32 v26, v24
    s_waitcnt lgkmcnt(0)
    ds_read2_b64 v[60:63], v26 offset0:0 offset1:4
    s_waitcnt lgkmcnt(0)
    ds_read2_b64 v[32:35], v26 offset0:8 offset1:12
    v_add_u32 v26, 64, v26
    s_mov_b64 exec, 1
    ds_add_u32 v70, v71 offset:2496
    s_mov_b64 exec, -1
    v_perm_b32 v80, v60, v60, v72
    v_perm_b32 v81, v60, v60, v73
    v_perm_b32 v82, v60, v60, v74
    v_perm_b32 v83, v60, v60, v75
    v_perm_b32 v84, v60, v60, v76
    v_perm_b32 v85, v60, v60, v77
    v_perm_b32 v86, v60, v60, v78
    v_perm_b32 v87, v60, v60, v79
    v_perm_b32 v88, v61, v61, v72
    v_perm_b32 v89, v61, v61, v73
    v_perm_b32 v90, v61, v61, v74
    v_perm_b32 v91, v61, v61, v75
    v_perm_b32 v92, v61, v61, v76
    v_perm_b32 v93, v61, v61, v77
    v_perm_b32 v94, v61, v61, v78
    v_perm_b32 v95, v61, v61, v79
    v_mfma_f32_16x16x32_bf16 v[64:67], v[80:83], v[128:131], v[64:67]
    v_mfma_f32_16x16x32_bf16 v[64:67], v[84:87], v[132:135], v[64:67]
    v_mfma_f32_16x16x32_bf16 v[64:67], v[88:91], v[136:139], v[64:67]
    v_mfma_f32_16x16x32_bf16 v[64:67], v[92:95], v[140:143], v[64:67]
    s_waitcnt vmcnt(5)
    buffer_load_dwordx4 v[188:191], v3, s[12:15], s40 offen offset:768 nt
    s_add_u32 s50, s50, 1
    s_and_b32 s53, s50, 63
    s_and_b32 s41, s53, 1
    s_lshl_b32 s41, s41, 12
    s_xor_b32 s40, s49, s41
    s_and_b32 s41, s53, 2
    s_lshl_b32 s41, s41, 16
    s_xor_b32 s40, s40, s41
    s_and_b32 s41, s53, 4
    s_lshl_b32 s41, s41, 14
    s_xor_b32 s40, s40, s41
    s_and_b32 s41, s53, 24
    s_lshl_b32 s41, s41, 15
    s_xor_b32 s40, s40, s41
    s_and_b32 s41, s53, 16
    s_lshl_b32 s41, s41, 10
    s_xor_b32 s40, s40, s41
    s_and_b32 s41, s53, 32
    s_lshl_b32 s41, s41, 9
    s_xor_b32 s40, s40, s41
    v_perm_b32 v80, v62, v62, v72
    v_perm_b32 v81, v62, v62, v73
    v_perm_b32 v82, v62, v62, v74
    v_perm_b32 v83, v62, v62, v75
    v_perm_b32 v84, v62, v62, v76
    v_perm_b32 v85, v62, v62, v77
    v_perm_b32 v86, v62, v62, v78
    v_perm_b32 v87, v62, v62, v79
    v_perm_b32 v88, v63, v63, v72
    v_perm_b32 v89, v63, v63, v73
    v_perm_b32 v90, v63, v63, v74
    v_perm_b32 v91, v63, v63, v75
    v_perm_b32 v92, v63, v63, v76
    v_perm_b32 v93, v63, v63, v77
    v_perm_b32 v94, v63, v63, v78
    v_perm_b32 v95, v63, v63, v79
    v_mfma_f32_16x16x32_bf16 v[64:67], v[80:83], v[144:147], v[64:67]
    v_mfma_f32_16x16x32_bf16 v[64:67], v[84:87], v[148:151], v[64:67]
    v_mfma_f32_16x16x32_bf16 v[64:67], v[88:91], v[152:155], v[64:67]
    v_mfma_f32_16x16x32_bf16 v[64:67], v[92:95], v[156:159], v[64:67]
    s_mov_b32 s44, 14
    ds_read_b32 v31, v70 offset:2500
    v_mov_b32 v30, 109
    s_mov_b32 s51, 108
    s_waitcnt lgkmcnt(0)
    v_readfirstlane_b32 s43, v31
    v_readfirstlane_b32 s45, v30
    s_nop 0
    s_sub_i32 s45, s45, s51
    s_add_u32 s51, s51, 8
    s_cmp_ge_i32 s45, 3
    s_addc_u32 s43, s43, 0
    s_cmp_le_i32 s45, 0
    s_subb_u32 s43, s43, 0
    s_cmp_eq_u32 s43, 0
    s_cbranch_scc1 L_v0
    s_cmp_eq_u32 s43, 1
    s_cbranch_scc1 L_v1
    s_cmp_eq_u32 s43, 2
    s_cbranch_scc1 L_v2
    s_cmp_eq_u32 s43, 3
    s_cbranch_scc1 L_v3
    s_cmp_eq_u32 s43, 4
    s_cbranch_scc1 L_v4
    s_cmp_eq_u32 s43, 5
    s_cbranch_scc1 L_v5
    s_branch L_v6
L_v0:
    s_waitcnt lgkmcnt(0)
    ds_read2_b64 v[60:63], v26 offset0:8 offset1:12
    v_add_u32 v26, 64, v26
    s_mov_b64 exec, 1
    ds_add_u32 v70, v71 offset:2496
    s_mov_b64 exec, -1
    v_perm_b32 v80, v32, v32, v72
    v_perm_b32 v81, v32, v32, v73
    v_perm_b32 v82, v32, v32, v74
    v_perm_b32 v83, v32, v32, v75
    v_perm_b32 v84, v32, v32, v76
    v_perm_b32 v85, v32, v32, v77
    v_perm_b32 v86, v32, v32, v78
    v_perm_b32 v87, v32, v32, v79
    v_perm_b32 v88, v33, v33, v72
    v_perm_b32 v89, v33, v33, v73
    v_perm_b32 v90, v33, v33, v74
    v_perm_b32 v91, v33, v33, v75
    v_perm_b32 v92, v33, v33, v76
    v_perm_b32 v93, v33, v33, v77
    v_perm_b32 v94, v33, v33, v78
    v_perm_b32 v95, v33, v33, v79
    v_mfma_f32_16x16x32_bf16 v[64:67], v[80:83], v[96:99], v[64:67]
    v_mfma_f32_16x16x32_bf16 v[64:67], v[84:87], v[100:103], v[64:67]
    v_mfma_f32_16x16x32_bf16 v[64:67], v[88:91], v[104:107], v[64:67]
    v_mfma_f32_16x16x32_bf16 v[64:67], v[92:95], v[108:111], v[64:67]
    s_waitcnt vmcnt(3)
    buffer_load_dwordx4 v[96:99], v3, s[12:15], s40 offen offset:0 nt
    s_waitcnt vmcnt(3)
    buffer_load_dwordx4 v[100:103], v3, s[12:15], s40 offen offset:256 nt
    s_waitcnt vmcnt(3)
    buffer_load_dwordx4 v[104:107], v3, s[12:15], s40 offen offset:512 nt
    s_waitcnt vmcnt(3)
    buffer_load_dwordx4 v[108:111], v3, s[12:15], s40 offen offset:768 nt
    s_add_u32 s50, s50, 1
    s_and_b32 s53, s50, 63
    s_and_b32 s41, s53, 1
    s_lshl_b32 s41, s41, 12
    s_xor_b32 s40, s49, s41
    s_and_b32 s41, s53, 2
    s_lshl_b32 s41, s41, 16
    s_xor_b32 s40, s40, s41
    s_and_b32 s41, s53, 4
    s_lshl_b32 s41, s41, 14
    s_xor_b32 s40, s40, s41
    s_and_b32 s41, s53, 24
    s_lshl_b32 s41, s41, 15
    s_xor_b32 s40, s40, s41
    s_and_b32 s41, s53, 16
    s_lshl_b32 s41, s41, 10
    s_xor_b32 s40, s40, s41
    s_and_b32 s41, s53, 32
    s_lshl_b32 s41, s41, 9
    s_xor_b32 s40, s40, s41
    v_perm_b32 v80, v34, v34, v72
    v_perm_b32 v81, v34, v34, v73
    v_perm_b32 v82, v34, v34, v74
    v_perm_b32 v83, v34, v34, v75
    v_perm_b32 v84, v34, v34, v76
    v_perm_b32 v85, v34, v34, v77
    v_perm_b32 v86, v34, v34, v78
    v_perm_b32 v87, v34, v34, v79
    v_perm_b32 v88, v35, v35, v72
    v_perm_b32 v89, v35, v35, v73
    v_perm_b32 v90, v35, v35, v74
    v_perm_b32 v91, v35, v35, v75
    v_perm_b32 v92, v35, v35, v76
    v_perm_b32 v93, v35, v35, v77
    v_perm_b32 v94, v35, v35, v78
    v_perm_b32 v95, v35, v35, v79
    v_mfma_f32_16x16x32_bf16 v[64:67], v[80:83], v[112:115], v[64:67]
    v_mfma_f32_16x16x32_bf16 v[64:67], v[84:87], v[116:119], v[64:67]
    v_mfma_f32_16x16x32_bf16 v[64:67], v[88:91], v[120:123], v[64:67]
    v_mfma_f32_16x16x32_bf16 v[64:67], v[92:95], v[124:127], v[64:67]
    s_waitcnt vmcnt(3)
    buffer_load_dwordx4 v[112:115], v3, s[12:15], s40 offen offset:0 nt
    s_waitcnt vmcnt(3)
    buffer_load_dwordx4 v[116:119], v3, s[12:15], s40 offen offset:256 nt
    s_waitcnt vmcnt(3)
    buffer_load_dwordx4 v[120:123], v3, s[12:15], s40 offen offset:512 nt
    s_waitcnt vmcnt(3)
    buffer_load_dwordx4 v[124:127], v3, s[12:15], s40 offen offset:768 nt
    s_add_u32 s50, s50, 1
    s_and_b32 s53, s50, 63
    s_and_b32 s41, s53, 1
    s_lshl_b32 s41, s41, 12
    s_xor_b32 s40, s49, s41
    s_and_b32 s41, s53, 2
    s_lshl_b32 s41, s41, 16
    s_xor_b32 s40, s40, s41
    s_and_b32 s41, s53, 4
    s_lshl_b32 s41, s41, 14
    s_xor_b32 s40, s40, s41
    s_and_b32 s41, s53, 24
    s_lshl_b32 s41, s41, 15
    s_xor_b32 s40, s40, s41
    s_and_b32 s41, s53, 16
    s_lshl_b32 s41, s41, 10
    s_xor_b32 s40, s40, s41
    s_and_b32 s41, s53, 32
    s_lshl_b32 s41, s41, 9
    s_xor_b32 s40, s40, s41
    s_waitcnt lgkmcnt(0)
    ds_read2_b64 v[32:35], v26 offset0:8 offset1:12
    v_add_u32 v26, 64, v26
    s_mov_b64 exec, 1
    ds_add_rtn_u32 v30, v70, v71 offset:2496
    s_mov_b64 exec, -1
    ds_read_b32 v31, v70 offset:2500
    v_perm_b32 v80, v60, v60, v72
    v_perm_b32 v81, v60, v60, v73
    v_perm_b32 v82, v60, v60, v74
    v_perm_b32 v83, v60, v60, v75
    v_perm_b32 v84, v60, v60, v76
    v_perm_b32 v85, v60, v60, v77
    v_perm_b32 v86, v60, v60, v78
    v_perm_b32 v87, v60, v60, v79
    v_perm_b32 v88, v61, v61, v72
    v_perm_b32 v89, v61, v61, v73
    v_perm_b32 v90, v61, v61, v74
    v_perm_b32 v91, v61, v61, v75
    v_perm_b32 v92, v61, v61, v76
    v_perm_b32 v93, v61, v61, v77
    v_perm_b32 v94, v61, v61, v78
    v_perm_b32 v95, v61, v61, v79
    v_mfma_f32_16x16x32_bf16 v[64:67], v[80:83], v[160:163], v[64:67]
    v_mfma_f32_16x16x32_bf16 v[64:67], v[84:87], v[164:167], v[64:67]
    v_mfma_f32_16x16x32_bf16 v[64:67], v[88:91], v[168:171], v[64:67]
    v_mfma_f32_16x16x32_bf16 v[64:67], v[92:95], v[172:175], v[64:67]
    s_waitcnt vmcnt(3)
    buffer_load_dwordx4 v[160:163], v3, s[12:15], s40 offen offset:0 nt
    s_waitcnt vmcnt(3)
    buffer_load_dwordx4 v[164:167], v3, s[12:15], s40 offen offset:256 nt
    s_waitcnt vmcnt(3)
    buffer_load_dwordx4 v[168:171], v3, s[12:15], s40 offen offset:512 nt
    s_waitcnt vmcnt(3)
    buffer_load_dwordx4 v[172:175], v3, s[12:15], s40 offen offset:768 nt
    s_add_u32 s50, s50, 1
    s_and_b32 s53, s50, 63
    s_and_b32 s41, s53, 1
    s_lshl_b32 s41, s41, 12
    s_xor_b32 s40, s49, s41
    s_and_b32 s41, s53, 2
    s_lshl_b32 s41, s41, 16
    s_xor_b32 s40, s40, s41
    s_and_b32 s41, s53, 4
    s_lshl_b32 s41, s41, 14
    s_xor_b32 s40, s40, s41
    s_and_b32 s41, s53, 24
    s_lshl_b32 s41, s41, 15
    s_xor_b32 s40, s40, s41
    s_and_b32 s41, s53, 16
    s_lshl_b32 s41, s41, 10
    s_xor_b32 s40, s40, s41
    s_and_b32 s41, s53, 32
    s_lshl_b32 s41, s41, 9
    s_xor_b32 s40, s40, s41
    v_perm_b32 v80, v62, v62, v72
    v_perm_b32 v81, v62, v62, v73
    v_perm_b32 v82, v62, v62, v74
    v_perm_b32 v83, v62, v62, v75
    v_perm_b32 v84, v62, v62, v76
    v_perm_b32 v85, v62, v62, v77
    v_perm_b32 v86, v62, v62, v78
    v_perm_b32 v87, v62, v62, v79
    v_perm_b32 v88, v63, v63, v72
    v_perm_b32 v89, v63, v63, v73
    v_perm_b32 v90, v63, v63, v74
    v_perm_b32 v91, v63, v63, v75
    v_perm_b32 v92, v63, v63, v76
    v_perm_b32 v93, v63, v63, v77
    v_perm_b32 v94, v63, v63, v78
    v_perm_b32 v95, v63, v63, v79
    v_mfma_f32_16x16x32_bf16 v[64:67], v[80:83], v[176:179], v[64:67]
    v_mfma_f32_16x16x32_bf16 v[64:67], v[84:87], v[180:183], v[64:67]
    v_mfma_f32_16x16x32_bf16 v[64:67], v[88:91], v[184:187], v[64:67]
    v_mfma_f32_16x16x32_bf16 v[64:67], v[92:95], v[188:191], v[64:67]
    s_waitcnt vmcnt(3)
    buffer_load_dwordx4 v[176:179], v3, s[12:15], s40 offen offset:0 nt
    s_waitcnt vmcnt(3)
    buffer_load_dwordx4 v[180:183], v3, s[12:15], s40 offen offset:256 nt
    s_waitcnt vmcnt(3)
    buffer_load_dwordx4 v[184:187], v3, s[12:15], s40 offen offset:512 nt
    s_waitcnt vmcnt(3)
    buffer_load_dwordx4 v[188:191], v3, s[12:15], s40 offen offset:768 nt
    s_add_u32 s50, s50, 1
    s_and_b32 s53, s50, 63
    s_and_b32 s41, s53, 1
    s_lshl_b32 s41, s41, 12
    s_xor_b32 s40, s49, s41
    s_and_b32 s41, s53, 2
    s_lshl_b32 s41, s41, 16
    s_xor_b32 s40, s40, s41
    s_and_b32 s41, s53, 4
    s_lshl_b32 s41, s41, 14
    s_xor_b32 s40, s40, s41
    s_and_b32 s41, s53, 24
    s_lshl_b32 s41, s41, 15
    s_xor_b32 s40, s40, s41
    s_and_b32 s41, s53, 16
    s_lshl_b32 s41, s41, 10
    s_xor_b32 s40, s40, s41
    s_and_b32 s41, s53, 32
    s_lshl_b32 s41, s41, 9
    s_xor_b32 s40, s40, s41
    s_sub_u32 s44, s44, 1
    s_cmp_eq_u32 s44, 0
    s_cbranch_scc1 L_v_end
    s_waitcnt lgkmcnt(0)
    v_readfirstlane_b32 s43, v31
    v_readfirstlane_b32 s45, v30
    s_nop 0
    s_sub_i32 s45, s45, s51
    s_add_u32 s51, s51, 8
    s_cmp_ge_i32 s45, 3
    s_addc_u32 s43, s43, 0
    s_cmp_le_i32 s45, 0
    s_subb_u32 s43, s43, 0
    s_cmp_eq_u32 s43, 0
    s_cbranch_scc1 L_v0
    s_cmp_eq_u32 s43, 1
    s_cbranch_scc1 L_v1
    s_cmp_eq_u32 s43, 2
    s_cbranch_scc1 L_v2
    s_cmp_eq_u32 s43, 3
    s_cbranch_scc1 L_v3
    s_cmp_eq_u32 s43, 4
    s_cbranch_scc1 L_v4
    s_cmp_eq_u32 s43, 5
    s_cbranch_scc1 L_v5
    s_branch L_v6
L_v1:
    s_waitcnt lgkmcnt(0)
    ds_read2_b64 v[60:63], v26 offset0:8 offset1:12
    v_add_u32 v26, 64, v26
    s_mov_b64 exec, 1
    ds_add_u32 v70, v71 offset:2496
    s_mov_b64 exec, -1
    v_perm_b32 v80, v32, v32, v72
    v_perm_b32 v81, v32, v32, v73
    v_perm_b32 v82, v32, v32, v74
    v_perm_b32 v83, v32, v32, v75
    v_perm_b32 v84, v32, v32, v76
    v_perm_b32 v85, v32, v32, v77
    v_perm_b32 v86, v32, v32, v78
    v_perm_b32 v87, v32, v32, v79
    v_perm_b32 v88, v33, v33, v72
    v_perm_b32 v89, v33, v33, v73
    v_perm_b32 v90, v33, v33, v74
    v_perm_b32 v91, v33, v33, v75
    v_perm_b32 v92, v33, v33, v76
    v_perm_b32 v93, v33, v33, v77
    v_perm_b32 v94, v33, v33, v78
    v_perm_b32 v95, v33, v33, v79
    v_mfma_f32_16x16x32_bf16 v[64:67], v[80:83], v[96:99], v[64:67]
    v_mfma_f32_16x16x32_bf16 v[64:67], v[84:87], v[100:103], v[64:67]
    v_mfma_f32_16x16x32_bf16 v[64:67], v[88:91], v[104:107], v[64:67]
    v_mfma_f32_16x16x32_bf16 v[64:67], v[92:95], v[108:111], v[64:67]
    s_waitcnt vmcnt(4)
    buffer_load_dwordx4 v[96:99], v3, s[12:15], s40 offen offset:0 nt
    s_waitcnt vmcnt(4)
    buffer_load_dwordx4 v[100:103], v3, s[12:15], s40 offen offset:256 nt
    s_waitcnt vmcnt(4)
    buffer_load_dwordx4 v[104:107], v3, s[12:15], s40 offen offset:512 nt
    s_waitcnt vmcnt(4)
    buffer_load_dwordx4 v[108:111], v3, s[12:15], s40 offen offset:768 nt
    s_add_u32 s50, s50, 1
    s_and_b32 s53, s50, 63
    s_and_b32 s41, s53, 1
    s_lshl_b32 s41, s41, 12
    s_xor_b32 s40, s49, s41
    s_and_b32 s41, s53, 2
    s_lshl_b32 s41, s41, 16
    s_xor_b32 s40, s40, s41
    s_and_b32 s41, s53, 4
    s_lshl_b32 s41, s41, 14
    s_xor_b32 s40, s40, s41
    s_and_b32 s41, s53, 24
    s_lshl_b32 s41, s41, 15
    s_xor_b32 s40, s40, s41
    s_and_b32 s41, s53, 16
    s_lshl_b32 s41, s41, 10
    s_xor_b32 s40, s40, s41
    s_and_b32 s41, s53, 32
    s_lshl_b32 s41, s41, 9
    s_xor_b32 s40, s40, s41
    v_perm_b32 v80, v34, v34, v72
    v_perm_b32 v81, v34, v34, v73
    v_perm_b32 v82, v34, v34, v74
    v_perm_b32 v83, v34, v34, v75
    v_perm_b32 v84, v34, v34, v76
    v_perm_b32 v85, v34, v34, v77
    v_perm_b32 v86, v34, v34, v78
    v_perm_b32 v87, v34, v34, v79
    v_perm_b32 v88, v35, v35, v72
    v_perm_b32 v89, v35, v35, v73
    v_perm_b32 v90, v35, v35, v74
    v_perm_b32 v91, v35, v35, v75
    v_perm_b32 v92, v35, v35, v76
    v_perm_b32 v93, v35, v35, v77
    v_perm_b32 v94, v35, v35, v78
    v_perm_b32 v95, v35, v35, v79
    v_mfma_f32_16x16x32_bf16 v[64:67], v[80:83], v[112:115], v[64:67]
    v_mfma_f32_16x16x32_bf16 v[64:67], v[84:87], v[116:119], v[64:67]
    v_mfma_f32_16x16x32_bf16 v[64:67], v[88:91], v[120:123], v[64:67]
    v_mfma_f32_16x16x32_bf16 v[64:67], v[92:95], v[124:127], v[64:67]
    s_waitcnt vmcnt(3)
    buffer_load_dwordx4 v[112:115], v3, s[12:15], s40 offen offset:0 nt
    s_waitcnt vmcnt(3)
    buffer_load_dwordx4 v[116:119], v3, s[12:15], s40 offen offset:256 nt
    s_waitcnt vmcnt(3)
    buffer_load_dwordx4 v[120:123], v3, s[12:15], s40 offen offset:512 nt
    s_waitcnt vmcnt(3)
    buffer_load_dwordx4 v[124:127], v3, s[12:15], s40 offen offset:768 nt
    s_add_u32 s50, s50, 1
    s_and_b32 s53, s50, 63
    s_and_b32 s41, s53, 1
    s_lshl_b32 s41, s41, 12
    s_xor_b32 s40, s49, s41
    s_and_b32 s41, s53, 2
    s_lshl_b32 s41, s41, 16
    s_xor_b32 s40, s40, s41
    s_and_b32 s41, s53, 4
    s_lshl_b32 s41, s41, 14
    s_xor_b32 s40, s40, s41
    s_and_b32 s41, s53, 24
    s_lshl_b32 s41, s41, 15
    s_xor_b32 s40, s40, s41
    s_and_b32 s41, s53, 16
    s_lshl_b32 s41, s41, 10
    s_xor_b32 s40, s40, s41
    s_and_b32 s41, s53, 32
    s_lshl_b32 s41, s41, 9
    s_xor_b32 s40, s40, s41
    s_waitcnt lgkmcnt(0)
    ds_read2_b64 v[32:35], v26 offset0:8 offset1:12
    v_add_u32 v26, 64, v26
    s_mov_b64 exec, 1
    ds_add_rtn_u32 v30, v70, v71 offset:2496
    s_mov_b64 exec, -1
    ds_read_b32 v31, v70 offset:2500
    v_perm_b32 v80, v60, v60, v72
    v_perm_b32 v81, v60, v60, v73
    v_perm_b32 v82, v60, v60, v74
    v_perm_b32 v83, v60, v60, v75
    v_perm_b32 v84, v60, v60, v76
    v_perm_b32 v85, v60, v60, v77
    v_perm_b32 v86, v60, v60, v78
    v_perm_b32 v87, v60, v60, v79
    v_perm_b32 v88, v61, v61, v72
    v_perm_b32 v89, v61, v61, v73
    v_perm_b32 v90, v61, v61, v74
    v_perm_b32 v91, v61, v61, v75
    v_perm_b32 v92, v61, v61, v76
    v_perm_b32 v93, v61, v61, v77
    v_perm_b32 v94, v61, v61, v78
    v_perm_b32 v95, v61, v61, v79
    v_mfma_f32_16x16x32_bf16 v[64:67], v[80:83], v[160:163], v[64:67]
    v_mfma_f32_16x16x32_bf16 v[64:67], v[84:87], v[164:167], v[64:67]
    v_mfma_f32_16x16x32_bf16 v[64:67], v[88:91], v[168:171], v[64:67]
    v_mfma_f32_16x16x32_bf16 v[64:67], v[92:95], v[172:175], v[64:67]
    buffer_load_dwordx4 v[160:163], v3, s[12:15], s40 offen offset:0 nt
    s_waitcnt vmcnt(4)
    buffer_load_dwordx4 v[164:167], v3, s[12:15], s40 offen offset:256 nt
    s_waitcnt vmcnt(4)
    buffer_load_dwordx4 v[168:171], v3, s[12:15], s40 offen offset:512 nt
    s_waitcnt vmcnt(4)
    buffer_load_dwordx4 v[172:175], v3, s[12:15], s40 offen offset:768 nt
    s_add_u32 s50, s50, 1
    s_and_b32 s53, s50, 63
    s_and_b32 s41, s53, 1
    s_lshl_b32 s41, s41, 12
    s_xor_b32 s40, s49, s41
    s_and_b32 s41, s53, 2
    s_lshl_b32 s41, s41, 16
    s_xor_b32 s40, s40, s41
    s_and_b32 s41, s53, 4
    s_lshl_b32 s41, s41, 14
    s_xor_b32 s40, s40, s41
    s_and_b32 s41, s53, 24
    s_lshl_b32 s41, s41, 15
    s_xor_b32 s40, s40, s41
    s_and_b32 s41, s53, 16
    s_lshl_b32 s41, s41, 10
    s_xor_b32 s40, s40, s41
    s_and_b32 s41, s53, 32
    s_lshl_b32 s41, s41, 9
    s_xor_b32 s40, s40, s41
    v_perm_b32 v80, v62, v62, v72
    v_perm_b32 v81, v62, v62, v73
    v_perm_b32 v82, v62, v62, v74
    v_perm_b32 v83, v62, v62, v75
    v_perm_b32 v84, v62, v62, v76
    v_perm_b32 v85, v62, v62, v77
    v_perm_b32 v86, v62, v62, v78
    v_perm_b32 v87, v62, v62, v79
    v_perm_b32 v88, v63, v63, v72
    v_perm_b32 v89, v63, v63, v73
    v_perm_b32 v90, v63, v63, v74
    v_perm_b32 v91, v63, v63, v75
    v_perm_b32 v92, v63, v63, v76
    v_perm_b32 v93, v63, v63, v77
    v_perm_b32 v94, v63, v63, v78
    v_perm_b32 v95, v63, v63, v79
    v_mfma_f32_16x16x32_bf16 v[64:67], v[80:83], v[176:179], v[64:67]
    v_mfma_f32_16x16x32_bf16 v[64:67], v[84:87], v[180:183], v[64:67]
    v_mfma_f32_16x16x32_bf16 v[64:67], v[88:91], v[184:187], v[64:67]
    v_mfma_f32_16x16x32_bf16 v[64:67], v[92:95], v[188:191], v[64:67]
    s_waitcnt vmcnt(3)
    buffer_load_dwordx4 v[176:179], v3, s[12:15], s40 offen offset:0 nt
    s_waitcnt vmcnt(3)
    buffer_load_dwordx4 v[180:183], v3, s[12:15], s40 offen offset:256 nt
    s_waitcnt vmcnt(3)
    buffer_load_dwordx4 v[184:187], v3, s[12:15], s40 offen offset:512 nt
    s_waitcnt vmcnt(3)
    buffer_load_dwordx4 v[188:191], v3, s[12:15], s40 offen offset:768 nt
    s_add_u32 s50, s50, 1
    s_and_b32 s53, s50, 63
    s_and_b32 s41, s53, 1
    s_lshl_b32 s41, s41, 12
    s_xor_b32 s40, s49, s41
    s_and_b32 s41, s53, 2
    s_lshl_b32 s41, s41, 16
    s_xor_b32 s40, s40, s41
    s_and_b32 s41, s53, 4
    s_lshl_b32 s41, s41, 14
    s_xor_b32 s40, s40, s41
    s_and_b32 s41, s53, 24
    s_lshl_b32 s41, s41, 15
    s_xor_b32 s40, s40, s41
    s_and_b32 s41, s53, 16
    s_lshl_b32 s41, s41, 10
    s_xor_b32 s40, s40, s41
    s_and_b32 s41, s53, 32
    s_lshl_b32 s41, s41, 9
    s_xor_b32 s40, s40, s41
    s_sub_u32 s44, s44, 1
    s_cmp_eq_u32 s44, 0
    s_cbranch_scc1 L_v_end
    s_waitcnt lgkmcnt(0)
    v_readfirstlane_b32 s43, v31
    v_readfirstlane_b32 s45, v30
    s_nop 0
    s_sub_i32 s45, s45, s51
    s_add_u32 s51, s51, 8
    s_cmp_ge_i32 s45, 3
    s_addc_u32 s43, s43, 0
    s_cmp_le_i32 s45, 0
    s_subb_u32 s43, s43, 0
    s_cmp_eq_u32 s43, 0
    s_cbranch_scc1 L_v0
    s_cmp_eq_u32 s43, 1
    s_cbranch_scc1 L_v1
    s_cmp_eq_u32 s43, 2
    s_cbranch_scc1 L_v2
    s_cmp_eq_u32 s43, 3
    s_cbranch_scc1 L_v3
    s_cmp_eq_u32 s43, 4
    s_cbranch_scc1 L_v4
    s_cmp_eq_u32 s43, 5
    s_cbranch_scc1 L_v5
    s_branch L_v6
L_v2:
    s_waitcnt lgkmcnt(0)
    ds_read2_b64 v[60:63], v26 offset0:8 offset1:12
    v_add_u32 v26, 64, v26
    s_mov_b64 exec, 1
    ds_add_u32 v70, v71 offset:2496
    s_mov_b64 exec, -1
    v_perm_b32 v80, v32, v32, v72
    v_perm_b32 v81, v32, v32, v73
    v_perm_b32 v82, v32, v32, v74
    v_perm_b32 v83, v32, v32, v75
    v_perm_b32 v84, v32, v32, v76
    v_perm_b32 v85, v32, v32, v77
    v_perm_b32 v86, v32, v32, v78
    v_perm_b32 v87, v32, v32, v79
    v_perm_b32 v88, v33, v33, v72
    v_perm_b32 v89, v33, v33, v73
    v_perm_b32 v90, v33, v33, v74
    v_perm_b32 v91, v33, v33, v75
    v_perm_b32 v92, v33, v33, v76
    v_perm_b32 v93, v33, v33, v77
    v_perm_b32 v94, v33, v33, v78
    v_perm_b32 v95, v33, v33, v79
    v_mfma_f32_16x16x32_bf16 v[64:67], v[80:83], v[96:99], v[64:67]
    v_mfma_f32_16x16x32_bf16 v[64:67], v[84:87], v[100:103], v[64:67]
    v_mfma_f32_16x16x32_bf16 v[64:67], v[88:91], v[104:107], v[64:67]
    v_mfma_f32_16x16x32_bf16 v[64:67], v[92:95], v[108:111], v[64:67]
    s_waitcnt vmcnt(4)
    buffer_load_dwordx4 v[96:99], v3, s[12:15], s40 offen offset:0 nt
    s_waitcnt vmcnt(4)
    buffer_load_dwordx4 v[100:103], v3, s[12:15], s40 offen offset:256 nt
    s_waitcnt vmcnt(4)
    buffer_load_dwordx4 v[104:107], v3, s[12:15], s40 offen offset:512 nt
    s_waitcnt vmcnt(4)
    buffer_load_dwordx4 v[108:111], v3, s[12:15], s40 offen offset:768 nt
    s_add_u32 s50, s50, 1
    s_and_b32 s53, s50, 63
    s_and_b32 s41, s53, 1
    s_lshl_b32 s41, s41, 12
    s_xor_b32 s40, s49, s41
    s_and_b32 s41, s53, 2
    s_lshl_b32 s41, s41, 16
    s_xor_b32 s40, s40, s41
    s_and_b32 s41, s53, 4
    s_lshl_b32 s41, s41, 14
    s_xor_b32 s40, s40, s41
    s_and_b32 s41, s53, 24
    s_lshl_b32 s41, s41, 15
    s_xor_b32 s40, s40, s41
    s_and_b32 s41, s53, 16
    s_lshl_b32 s41, s41, 10
    s_xor_b32 s40, s40, s41
    s_and_b32 s41, s53, 32
    s_lshl_b32 s41, s41, 9
    s_xor_b32 s40, s40, s41
    v_perm_b32 v80, v34, v34, v72
    v_perm_b32 v81, v34, v34, v73
    v_perm_b32 v82, v34, v34, v74
    v_perm_b32 v83, v34, v34, v75
    v_perm_b32 v84, v34, v34, v76
    v_perm_b32 v85, v34, v34, v77
    v_perm_b32 v86, v34, v34, v78
    v_perm_b32 v87, v34, v34, v79
    v_perm_b32 v88, v35, v35, v72
    v_perm_b32 v89, v35, v35, v73
    v_perm_b32 v90, v35, v35, v74
    v_perm_b32 v91, v35, v35, v75
    v_perm_b32 v92, v35, v35, v76
    v_perm_b32 v93, v35, v35, v77
    v_perm_b32 v94, v35, v35, v78
    v_perm_b32 v95, v35, v35, v79
    v_mfma_f32_16x16x32_bf16 v[64:67], v[80:83], v[112:115], v[64:67]
    v_mfma_f32_16x16x32_bf16 v[64:67], v[84:87], v[116:119], v[64:67]
    v_mfma_f32_16x16x32_bf16 v[64:67], v[88:91], v[120:123], v[64:67]
    v_mfma_f32_16x16x32_bf16 v[64:67], v[92:95], v[124:127], v[64:67]
    s_waitcnt vmcnt(4)
    buffer_load_dwordx4 v[112:115], v3, s[12:15], s40 offen offset:0 nt
    s_waitcnt vmcnt(4)
    buffer_load_dwordx4 v[116:119], v3, s[12:15], s40 offen offset:256 nt
    s_waitcnt vmcnt(4)
    buffer_load_dwordx4 v[120:123], v3, s[12:15], s40 offen offset:512 nt
    s_waitcnt vmcnt(4)
    buffer_load_dwordx4 v[124:127], v3, s[12:15], s40 offen offset:768 nt
    s_add_u32 s50, s50, 1
    s_and_b32 s53, s50, 63
    s_and_b32 s41, s53, 1
    s_lshl_b32 s41, s41, 12
    s_xor_b32 s40, s49, s41
    s_and_b32 s41, s53, 2
    s_lshl_b32 s41, s41, 16
    s_xor_b32 s40, s40, s41
    s_and_b32 s41, s53, 4
    s_lshl_b32 s41, s41, 14
    s_xor_b32 s40, s40, s41
    s_and_b32 s41, s53, 24
    s_lshl_b32 s41, s41, 15
    s_xor_b32 s40, s40, s41
    s_and_b32 s41, s53, 16
    s_lshl_b32 s41, s41, 10
    s_xor_b32 s40, s40, s41
    s_and_b32 s41, s53, 32
    s_lshl_b32 s41, s41, 9
    s_xor_b32 s40, s40, s41
    s_waitcnt lgkmcnt(0)
    ds_read2_b64 v[32:35], v26 offset0:8 offset1:12
    v_add_u32 v26, 64, v26
    s_mov_b64 exec, 1
    ds_add_rtn_u32 v30, v70, v71 offset:2496
    s_mov_b64 exec, -1
    ds_read_b32 v31, v70 offset:2500
    v_perm_b32 v80, v60, v60, v72
    v_perm_b32 v81, v60, v60, v73
    v_perm_b32 v82, v60, v60, v74
    v_perm_b32 v83, v60, v60, v75
    v_perm_b32 v84, v60, v60, v76
    v_perm_b32 v85, v60, v60, v77
    v_perm_b32 v86, v60, v60, v78
    v_perm_b32 v87, v60, v60, v79
    v_perm_b32 v88, v61, v61, v72
    v_perm_b32 v89, v61, v61, v73
    v_perm_b32 v90, v61, v61, v74
    v_perm_b32 v91, v61, v61, v75
    v_perm_b32 v92, v61, v61, v76
    v_perm_b32 v93, v61, v61, v77
    v_perm_b32 v94, v61, v61, v78
    v_perm_b32 v95, v61, v61, v79
    v_mfma_f32_16x16x32_bf16 v[64:67], v[80:83], v[160:163], v[64:67]
    v_mfma_f32_16x16x32_bf16 v[64:67], v[84:87], v[164:167], v[64:67]
    v_mfma_f32_16x16x32_bf16 v[64:67], v[88:91], v[168:171], v[64:67]
    v_mfma_f32_16x16x32_bf16 v[64:67], v[92:95], v[172:175], v[64:67]
    s_waitcnt vmcnt(4)
    buffer_load_dwordx4 v[160:163], v3, s[12:15], s40 offen offset:0 nt
    s_waitcnt vmcnt(4)
    buffer_load_dwordx4 v[164:167], v3, s[12:15], s40 offen offset:256 nt
    s_waitcnt vmcnt(4)
    buffer_load_dwordx4 v[168:171], v3, s[12:15], s40 offen offset:512 nt
    s_waitcnt vmcnt(4)
    buffer_load_dwordx4 v[172:175], v3, s[12:15], s40 offen offset:768 nt
    s_add_u32 s50, s50, 1
    s_and_b32 s53, s50, 63
    s_and_b32 s41, s53, 1
    s_lshl_b32 s41, s41, 12
    s_xor_b32 s40, s49, s41
    s_and_b32 s41, s53, 2
    s_lshl_b32 s41, s41, 16
    s_xor_b32 s40, s40, s41
    s_and_b32 s41, s53, 4
    s_lshl_b32 s41, s41, 14
    s_xor_b32 s40, s40, s41
    s_and_b32 s41, s53, 24
    s_lshl_b32 s41, s41, 15
    s_xor_b32 s40, s40, s41
    s_and_b32 s41, s53, 16
    s_lshl_b32 s41, s41, 10
    s_xor_b32 s40, s40, s41
    s_and_b32 s41, s53, 32
    s_lshl_b32 s41, s41, 9
    s_xor_b32 s40, s40, s41
    v_perm_b32 v80, v62, v62, v72
    v_perm_b32 v81, v62, v62, v73
    v_perm_b32 v82, v62, v62, v74
    v_perm_b32 v83, v62, v62, v75
    v_perm_b32 v84, v62, v62, v76
    v_perm_b32 v85, v62, v62, v77
    v_perm_b32 v86, v62, v62, v78
    v_perm_b32 v87, v62, v62, v79
    v_perm_b32 v88, v63, v63, v72
    v_perm_b32 v89, v63, v63, v73
    v_perm_b32 v90, v63, v63, v74
    v_perm_b32 v91, v63, v63, v75
    v_perm_b32 v92, v63, v63, v76
    v_perm_b32 v93, v63, v63, v77
    v_perm_b32 v94, v63, v63, v78
    v_perm_b32 v95, v63, v63, v79
    v_mfma_f32_16x16x32_bf16 v[64:67], v[80:83], v[176:179], v[64:67]
    v_mfma_f32_16x16x32_bf16 v[64:67], v[84:87], v[180:183], v[64:67]
    v_mfma_f32_16x16x32_bf16 v[64:67], v[88:91], v[184:187], v[64:67]
    v_mfma_f32_16x16x32_bf16 v[64:67], v[92:95], v[188:191], v[64:67]
    s_waitcnt vmcnt(4)
    buffer_load_dwordx4 v[176:179], v3, s[12:15], s40 offen offset:0 nt
    s_waitcnt vmcnt(4)
    buffer_load_dwordx4 v[180:183], v3, s[12:15], s40 offen offset:256 nt
    s_waitcnt vmcnt(4)
    buffer_load_dwordx4 v[184:187], v3, s[12:15], s40 offen offset:512 nt
    s_waitcnt vmcnt(4)
    buffer_load_dwordx4 v[188:191], v3, s[12:15], s40 offen offset:768 nt
    s_add_u32 s50, s50, 1
    s_and_b32 s53, s50, 63
    s_and_b32 s41, s53, 1
    s_lshl_b32 s41, s41, 12
    s_xor_b32 s40, s49, s41
    s_and_b32 s41, s53, 2
    s_lshl_b32 s41, s41, 16
    s_xor_b32 s40, s40, s41
    s_and_b32 s41, s53, 4
    s_lshl_b32 s41, s41, 14
    s_xor_b32 s40, s40, s41
    s_and_b32 s41, s53, 24
    s_lshl_b32 s41, s41, 15
    s_xor_b32 s40, s40, s41
    s_and_b32 s41, s53, 16
    s_lshl_b32 s41, s41, 10
    s_xor_b32 s40, s40, s41
    s_and_b32 s41, s53, 32
    s_lshl_b32 s41, s41, 9
    s_xor_b32 s40, s40, s41
    s_sub_u32 s44, s44, 1
    s_cmp_eq_u32 s44, 0
    s_cbranch_scc1 L_v_end
    s_waitcnt lgkmcnt(0)
    v_readfirstlane_b32 s43, v31
    v_readfirstlane_b32 s45, v30
    s_nop 0
    s_sub_i32 s45, s45, s51
    s_add_u32 s51, s51, 8
    s_cmp_ge_i32 s45, 3
    s_addc_u32 s43, s43, 0
    s_cmp_le_i32 s45, 0
    s_subb_u32 s43, s43, 0
    s_cmp_eq_u32 s43, 0
    s_cbranch_scc1 L_v0
    s_cmp_eq_u32 s43, 1
    s_cbranch_scc1 L_v1
    s_cmp_eq_u32 s43, 2
    s_cbranch_scc1 L_v2
    s_cmp_eq_u32 s43, 3
    s_cbranch_scc1 L_v3
    s_cmp_eq_u32 s43, 4
    s_cbranch_scc1 L_v4
    s_cmp_eq_u32 s43, 5
    s_cbranch_scc1 L_v5
    s_branch L_v6
L_v3:
    s_waitcnt lgkmcnt(0)
    ds_read2_b64 v[60:63], v26 offset0:8 offset1:12
    v_add_u32 v26, 64, v26
    s_mov_b64 exec, 1
    ds_add_u32 v70, v71 offset:2496
    s_mov_b64 exec, -1
    v_perm_b32 v80, v32, v32, v72
    v_perm_b32 v81, v32, v32, v73
    v_perm_b32 v82, v32, v32, v74
    v_perm_b32 v83, v32, v32, v75
    v_perm_b32 v84, v32, v32, v76
    v_perm_b32 v85, v32, v32, v77
    v_perm_b32 v86, v32, v32, v78
    v_perm_b32 v87, v32, v32, v79
    v_perm_b32 v88, v33, v33, v72
    v_perm_b32 v89, v33, v33, v73
    v_perm_b32 v90, v33, v33, v74
    v_perm_b32 v91, v33, v33, v75
    v_perm_b32 v92, v33, v33, v76
    v_perm_b32 v93, v33, v33, v77
    v_perm_b32 v94, v33, v33, v78
    v_perm_b32 v95, v33, v33, v79
    v_mfma_f32_16x16x32_bf16 v[64:67], v[80:83], v[96:99], v[64:67]
    v_mfma_f32_16x16x32_bf16 v[64:67], v[84:87], v[100:103], v[64:67]
    v_mfma_f32_16x16x32_bf16 v[64:67], v[88:91], v[104:107], v[64:67]
    v_mfma_f32_16x16x32_bf16 v[64:67], v[92:95], v[108:111], v[64:67]
    s_waitcnt vmcnt(5)
    buffer_load_dwordx4 v[96:99], v3, s[12:15], s40 offen offset:0 nt
    s_waitcnt vmcnt(5)
    buffer_load_dwordx4 v[100:103], v3, s[12:15], s40 offen offset:256 nt
    s_waitcnt vmcnt(5)
    buffer_load_dwordx4 v[104:107], v3, s[12:15], s40 offen offset:512 nt
    s_waitcnt vmcnt(5)
    buffer_load_dwordx4 v[108:111], v3, s[12:15], s40 offen offset:768 nt
    s_add_u32 s50, s50, 1
    s_and_b32 s53, s50, 63
    s_and_b32 s41, s53, 1
    s_lshl_b32 s41, s41, 12
    s_xor_b32 s40, s49, s41
    s_and_b32 s41, s53, 2
    s_lshl_b32 s41, s41, 16
    s_xor_b32 s40, s40, s41
    s_and_b32 s41, s53, 4
    s_lshl_b32 s41, s41, 14
    s_xor_b32 s40, s40, s41
    s_and_b32 s41, s53, 24
    s_lshl_b32 s41, s41, 15
    s_xor_b32 s40, s40, s41
    s_and_b32 s41, s53, 16
    s_lshl_b32 s41, s41, 10
    s_xor_b32 s40, s40, s41
    s_and_b32 s41, s53, 32
    s_lshl_b32 s41, s41, 9
    s_xor_b32 s40, s40, s41
    v_perm_b32 v80, v34, v34, v72
    v_perm_b32 v81, v34, v34, v73
    v_perm_b32 v82, v34, v34, v74
    v_perm_b32 v83, v34, v34, v75
    v_perm_b32 v84, v34, v34, v76
    v_perm_b32 v85, v34, v34, v77
    v_perm_b32 v86, v34, v34, v78
    v_perm_b32 v87, v34, v34, v79
    v_perm_b32 v88, v35, v35, v72
    v_perm_b32 v89, v35, v35, v73
    v_perm_b32 v90, v35, v35, v74
    v_perm_b32 v91, v35, v35, v75
    v_perm_b32 v92, v35, v35, v76
    v_perm_b32 v93, v35, v35, v77
    v_perm_b32 v94, v35, v35, v78
    v_perm_b32 v95, v35, v35, v79
    v_mfma_f32_16x16x32_bf16 v[64:67], v[80:83], v[112:115], v[64:67]
    v_mfma_f32_16x16x32_bf16 v[64:67], v[84:87], v[116:119], v[64:67]
    v_mfma_f32_16x16x32_bf16 v[64:67], v[88:91], v[120:123], v[64:67]
    v_mfma_f32_16x16x32_bf16 v[64:67], v[92:95], v[124:127], v[64:67]
    s_waitcnt vmcnt(4)
    buffer_load_dwordx4 v[112:115], v3, s[12:15], s40 offen offset:0 nt
    s_waitcnt vmcnt(4)
    buffer_load_dwordx4 v[116:119], v3, s[12:15], s40 offen offset:256 nt
    s_waitcnt vmcnt(4)
    buffer_load_dwordx4 v[120:123], v3, s[12:15], s40 offen offset:512 nt
    s_waitcnt vmcnt(4)
    buffer_load_dwordx4 v[124:127], v3, s[12:15], s40 offen offset:768 nt
    s_add_u32 s50, s50, 1
    s_and_b32 s53, s50, 63
    s_and_b32 s41, s53, 1
    s_lshl_b32 s41, s41, 12
    s_xor_b32 s40, s49, s41
    s_and_b32 s41, s53, 2
    s_lshl_b32 s41, s41, 16
    s_xor_b32 s40, s40, s41
    s_and_b32 s41, s53, 4
    s_lshl_b32 s41, s41, 14
    s_xor_b32 s40, s40, s41
    s_and_b32 s41, s53, 24
    s_lshl_b32 s41, s41, 15
    s_xor_b32 s40, s40, s41
    s_and_b32 s41, s53, 16
    s_lshl_b32 s41, s41, 10
    s_xor_b32 s40, s40, s41
    s_and_b32 s41, s53, 32
    s_lshl_b32 s41, s41, 9
    s_xor_b32 s40, s40, s41
    s_waitcnt lgkmcnt(0)
    ds_read2_b64 v[32:35], v26 offset0:8 offset1:12
    v_add_u32 v26, 64, v26
    s_mov_b64 exec, 1
    ds_add_rtn_u32 v30, v70, v71 offset:2496
    s_mov_b64 exec, -1
    ds_read_b32 v31, v70 offset:2500
    v_perm_b32 v80, v60, v60, v72
    v_perm_b32 v81, v60, v60, v73
    v_perm_b32 v82, v60, v60, v74
    v_perm_b32 v83, v60, v60, v75
    v_perm_b32 v84, v60, v60, v76
    v_perm_b32 v85, v60, v60, v77
    v_perm_b32 v86, v60, v60, v78
    v_perm_b32 v87, v60, v60, v79
    v_perm_b32 v88, v61, v61, v72
    v_perm_b32 v89, v61, v61, v73
    v_perm_b32 v90, v61, v61, v74
    v_perm_b32 v91, v61, v61, v75
    v_perm_b32 v92, v61, v61, v76
    v_perm_b32 v93, v61, v61, v77
    v_perm_b32 v94, v61, v61, v78
    v_perm_b32 v95, v61, v61, v79
    v_mfma_f32_16x16x32_bf16 v[64:67], v[80:83], v[160:163], v[64:67]
    v_mfma_f32_16x16x32_bf16 v[64:67], v[84:87], v[164:167], v[64:67]
    v_mfma_f32_16x16x32_bf16 v[64:67], v[88:91], v[168:171], v[64:67]
    v_mfma_f32_16x16x32_bf16 v[64:67], v[92:95], v[172:175], v[64:67]
    buffer_load_dwordx4 v[160:163], v3, s[12:15], s40 offen offset:0 nt
    s_waitcnt vmcnt(5)
    buffer_load_dwordx4 v[164:167], v3, s[12:15], s40 offen offset:256 nt
    s_waitcnt vmcnt(5)
    buffer_load_dwordx4 v[168:171], v3, s[12:15], s40 offen offset:512 nt
    s_waitcnt vmcnt(5)
    buffer_load_dwordx4 v[172:175], v3, s[12:15], s40 offen offset:768 nt
    s_add_u32 s50, s50, 1
    s_and_b32 s53, s50, 63
    s_and_b32 s41, s53, 1
    s_lshl_b32 s41, s41, 12
    s_xor_b32 s40, s49, s41
    s_and_b32 s41, s53, 2
    s_lshl_b32 s41, s41, 16
    s_xor_b32 s40, s40, s41
    s_and_b32 s41, s53, 4
    s_lshl_b32 s41, s41, 14
    s_xor_b32 s40, s40, s41
    s_and_b32 s41, s53, 24
    s_lshl_b32 s41, s41, 15
    s_xor_b32 s40, s40, s41
    s_and_b32 s41, s53, 16
    s_lshl_b32 s41, s41, 10
    s_xor_b32 s40, s40, s41
    s_and_b32 s41, s53, 32
    s_lshl_b32 s41, s41, 9
    s_xor_b32 s40, s40, s41
    v_perm_b32 v80, v62, v62, v72
    v_perm_b32 v81, v62, v62, v73
    v_perm_b32 v82, v62, v62, v74
    v_perm_b32 v83, v62, v62, v75
    v_perm_b32 v84, v62, v62, v76
    v_perm_b32 v85, v62, v62, v77
    v_perm_b32 v86, v62, v62, v78
    v_perm_b32 v87, v62, v62, v79
    v_perm_b32 v88, v63, v63, v72
    v_perm_b32 v89, v63, v63, v73
    v_perm_b32 v90, v63, v63, v74
    v_perm_b32 v91, v63, v63, v75
    v_perm_b32 v92, v63, v63, v76
    v_perm_b32 v93, v63, v63, v77
    v_perm_b32 v94, v63, v63, v78
    v_perm_b32 v95, v63, v63, v79
    v_mfma_f32_16x16x32_bf16 v[64:67], v[80:83], v[176:179], v[64:67]
    v_mfma_f32_16x16x32_bf16 v[64:67], v[84:87], v[180:183], v[64:67]
    v_mfma_f32_16x16x32_bf16 v[64:67], v[88:91], v[184:187], v[64:67]
    v_mfma_f32_16x16x32_bf16 v[64:67], v[92:95], v[188:191], v[64:67]
    s_waitcnt vmcnt(4)
    buffer_load_dwordx4 v[176:179], v3, s[12:15], s40 offen offset:0 nt
    s_waitcnt vmcnt(4)
    buffer_load_dwordx4 v[180:183], v3, s[12:15], s40 offen offset:256 nt
    s_waitcnt vmcnt(4)
    buffer_load_dwordx4 v[184:187], v3, s[12:15], s40 offen offset:512 nt
    s_waitcnt vmcnt(4)
    buffer_load_dwordx4 v[188:191], v3, s[12:15], s40 offen offset:768 nt
    s_add_u32 s50, s50, 1
    s_and_b32 s53, s50, 63
    s_and_b32 s41, s53, 1
    s_lshl_b32 s41, s41, 12
    s_xor_b32 s40, s49, s41
    s_and_b32 s41, s53, 2
    s_lshl_b32 s41, s41, 16
    s_xor_b32 s40, s40, s41
    s_and_b32 s41, s53, 4
    s_lshl_b32 s41, s41, 14
    s_xor_b32 s40, s40, s41
    s_and_b32 s41, s53, 24
    s_lshl_b32 s41, s41, 15
    s_xor_b32 s40, s40, s41
    s_and_b32 s41, s53, 16
    s_lshl_b32 s41, s41, 10
    s_xor_b32 s40, s40, s41
    s_and_b32 s41, s53, 32
    s_lshl_b32 s41, s41, 9
    s_xor_b32 s40, s40, s41
    s_sub_u32 s44, s44, 1
    s_cmp_eq_u32 s44, 0
    s_cbranch_scc1 L_v_end
    s_waitcnt lgkmcnt(0)
    v_readfirstlane_b32 s43, v31
    v_readfirstlane_b32 s45, v30
    s_nop 0
    s_sub_i32 s45, s45, s51
    s_add_u32 s51, s51, 8
    s_cmp_ge_i32 s45, 3
    s_addc_u32 s43, s43, 0
    s_cmp_le_i32 s45, 0
    s_subb_u32 s43, s43, 0
    s_cmp_eq_u32 s43, 0
    s_cbranch_scc1 L_v0
    s_cmp_eq_u32 s43, 1
    s_cbranch_scc1 L_v1
    s_cmp_eq_u32 s43, 2
    s_cbranch_scc1 L_v2
    s_cmp_eq_u32 s43, 3
    s_cbranch_scc1 L_v3
    s_cmp_eq_u32 s43, 4
    s_cbranch_scc1 L_v4
    s_cmp_eq_u32 s43, 5
    s_cbranch_scc1 L_v5
    s_branch L_v6
L_v4:
    s_waitcnt lgkmcnt(0)
    ds_read2_b64 v[60:63], v26 offset0:8 offset1:12
    v_add_u32 v26, 64, v26
    s_mov_b64 exec, 1
    ds_add_u32 v70, v71 offset:2496
    s_mov_b64 exec, -1
    v_perm_b32 v80, v32, v32, v72
    v_perm_b32 v81, v32, v32, v73
    v_perm_b32 v82, v32, v32, v74
    v_perm_b32 v83, v32, v32, v75
    v_perm_b32 v84, v32, v32, v76
    v_perm_b32 v85, v32, v32, v77
    v_perm_b32 v86, v32, v32, v78
    v_perm_b32 v87, v32, v32, v79
    v_perm_b32 v88, v33, v33, v72
    v_perm_b32 v89, v33, v33, v73
    v_perm_b32 v90, v33, v33, v74
    v_perm_b32 v91, v33, v33, v75
    v_perm_b32 v92, v33, v33, v76
    v_perm_b32 v93, v33, v33, v77
    v_perm_b32 v94, v33, v33, v78
    v_perm_b32 v95, v33, v33, v79
    v_mfma_f32_16x16x32_bf16 v[64:67], v[80:83], v[96:99], v[64:67]
    v_mfma_f32_16x16x32_bf16 v[64:67], v[84:87], v[100:103], v[64:67]
    v_mfma_f32_16x16x32_bf16 v[64:67], v[88:91], v[104:107], v[64:67]
    v_mfma_f32_16x16x32_bf16 v[64:67], v[92:95], v[108:111], v[64:67]
    s_waitcnt vmcnt(5)
    buffer_load_dwordx4 v[96:99], v3, s[12:15], s40 offen offset:0 nt
    s_waitcnt vmcnt(5)
    buffer_load_dwordx4 v[100:103], v3, s[12:15], s40 offen offset:256 nt
    s_waitcnt vmcnt(5)
    buffer_load_dwordx4 v[104:107], v3, s[12:15], s40 offen offset:512 nt
    s_waitcnt vmcnt(5)
    buffer_load_dwordx4 v[108:111], v3, s[12:15], s40 offen offset:768 nt
    s_add_u32 s50, s50, 1
    s_and_b32 s53, s50, 63
    s_and_b32 s41, s53, 1
    s_lshl_b32 s41, s41, 12
    s_xor_b32 s40, s49, s41
    s_and_b32 s41, s53, 2
    s_lshl_b32 s41, s41, 16
    s_xor_b32 s40, s40, s41
    s_and_b32 s41, s53, 4
    s_lshl_b32 s41, s41, 14
    s_xor_b32 s40, s40, s41
    s_and_b32 s41, s53, 24
    s_lshl_b32 s41, s41, 15
    s_xor_b32 s40, s40, s41
    s_and_b32 s41, s53, 16
    s_lshl_b32 s41, s41, 10
    s_xor_b32 s40, s40, s41
    s_and_b32 s41, s53, 32
    s_lshl_b32 s41, s41, 9
    s_xor_b32 s40, s40, s41
    v_perm_b32 v80, v34, v34, v72
    v_perm_b32 v81, v34, v34, v73
    v_perm_b32 v82, v34, v34, v74
    v_perm_b32 v83, v34, v34, v75
    v_perm_b32 v84, v34, v34, v76
    v_perm_b32 v85, v34, v34, v77
    v_perm_b32 v86, v34, v34, v78
    v_perm_b32 v87, v34, v34, v79
    v_perm_b32 v88, v35, v35, v72
    v_perm_b32 v89, v35, v35, v73
    v_perm_b32 v90, v35, v35, v74
    v_perm_b32 v91, v35, v35, v75
    v_perm_b32 v92, v35, v35, v76
    v_perm_b32 v93, v35, v35, v77
    v_perm_b32 v94, v35, v35, v78
    v_perm_b32 v95, v35, v35, v79
    v_mfma_f32_16x16x32_bf16 v[64:67], v[80:83], v[112:115], v[64:67]
    v_mfma_f32_16x16x32_bf16 v[64:67], v[84:87], v[116:119], v[64:67]
    v_mfma_f32_16x16x32_bf16 v[64:67], v[88:91], v[120:123], v[64:67]
    v_mfma_f32_16x16x32_bf16 v[64:67], v[92:95], v[124:127], v[64:67]
    s_waitcnt vmcnt(5)
    buffer_load_dwordx4 v[112:115], v3, s[12:15], s40 offen offset:0 nt
    s_waitcnt vmcnt(5)
    buffer_load_dwordx4 v[116:119], v3, s[12:15], s40 offen offset:256 nt
    s_waitcnt vmcnt(5)
    buffer_load_dwordx4 v[120:123], v3, s[12:15], s40 offen offset:512 nt
    s_waitcnt vmcnt(5)
    buffer_load_dwordx4 v[124:127], v3, s[12:15], s40 offen offset:768 nt
    s_add_u32 s50, s50, 1
    s_and_b32 s53, s50, 63
    s_and_b32 s41, s53, 1
    s_lshl_b32 s41, s41, 12
    s_xor_b32 s40, s49, s41
    s_and_b32 s41, s53, 2
    s_lshl_b32 s41, s41, 16
    s_xor_b32 s40, s40, s41
    s_and_b32 s41, s53, 4
    s_lshl_b32 s41, s41, 14
    s_xor_b32 s40, s40, s41
    s_and_b32 s41, s53, 24
    s_lshl_b32 s41, s41, 15
    s_xor_b32 s40, s40, s41
    s_and_b32 s41, s53, 16
    s_lshl_b32 s41, s41, 10
    s_xor_b32 s40, s40, s41
    s_and_b32 s41, s53, 32
    s_lshl_b32 s41, s41, 9
    s_xor_b32 s40, s40, s41
    s_waitcnt lgkmcnt(0)
    ds_read2_b64 v[32:35], v26 offset0:8 offset1:12
    v_add_u32 v26, 64, v26
    s_mov_b64 exec, 1
    ds_add_rtn_u32 v30, v70, v71 offset:2496
    s_mov_b64 exec, -1
    ds_read_b32 v31, v70 offset:2500
    v_perm_b32 v80, v60, v60, v72
    v_perm_b32 v81, v60, v60, v73
    v_perm_b32 v82, v60, v60, v74
    v_perm_b32 v83, v60, v60, v75
    v_perm_b32 v84, v60, v60, v76
    v_perm_b32 v85, v60, v60, v77
    v_perm_b32 v86, v60, v60, v78
    v_perm_b32 v87, v60, v60, v79
    v_perm_b32 v88, v61, v61, v72
    v_perm_b32 v89, v61, v61, v73
    v_perm_b32 v90, v61, v61, v74
    v_perm_b32 v91, v61, v61, v75
    v_perm_b32 v92, v61, v61, v76
    v_perm_b32 v93, v61, v61, v77
    v_perm_b32 v94, v61, v61, v78
    v_perm_b32 v95, v61, v61, v79
    v_mfma_f32_16x16x32_bf16 v[64:67], v[80:83], v[160:163], v[64:67]
    v_mfma_f32_16x16x32_bf16 v[64:67], v[84:87], v[164:167], v[64:67]
    v_mfma_f32_16x16x32_bf16 v[64:67], v[88:91], v[168:171], v[64:67]
    v_mfma_f32_16x16x32_bf16 v[64:67], v[92:95], v[172:175], v[64:67]
    s_waitcnt vmcnt(5)
    buffer_load_dwordx4 v[160:163], v3, s[12:15], s40 offen offset:0 nt
    s_waitcnt vmcnt(5)
    buffer_load_dwordx4 v[164:167], v3, s[12:15], s40 offen offset:256 nt
    s_waitcnt vmcnt(5)
    buffer_load_dwordx4 v[168:171], v3, s[12:15], s40 offen offset:512 nt
    s_waitcnt vmcnt(5)
    buffer_load_dwordx4 v[172:175], v3, s[12:15], s40 offen offset:768 nt
    s_add_u32 s50, s50, 1
    s_and_b32 s53, s50, 63
    s_and_b32 s41, s53, 1
    s_lshl_b32 s41, s41, 12
    s_xor_b32 s40, s49, s41
    s_and_b32 s41, s53, 2
    s_lshl_b32 s41, s41, 16
    s_xor_b32 s40, s40, s41
    s_and_b32 s41, s53, 4
    s_lshl_b32 s41, s41, 14
    s_xor_b32 s40, s40, s41
    s_and_b32 s41, s53, 24
    s_lshl_b32 s41, s41, 15
    s_xor_b32 s40, s40, s41
    s_and_b32 s41, s53, 16
    s_lshl_b32 s41, s41, 10
    s_xor_b32 s40, s40, s41
    s_and_b32 s41, s53, 32
    s_lshl_b32 s41, s41, 9
    s_xor_b32 s40, s40, s41
    v_perm_b32 v80, v62, v62, v72
    v_perm_b32 v81, v62, v62, v73
    v_perm_b32 v82, v62, v62, v74
    v_perm_b32 v83, v62, v62, v75
    v_perm_b32 v84, v62, v62, v76
    v_perm_b32 v85, v62, v62, v77
    v_perm_b32 v86, v62, v62, v78
    v_perm_b32 v87, v62, v62, v79
    v_perm_b32 v88, v63, v63, v72
    v_perm_b32 v89, v63, v63, v73
    v_perm_b32 v90, v63, v63, v74
    v_perm_b32 v91, v63, v63, v75
    v_perm_b32 v92, v63, v63, v76
    v_perm_b32 v93, v63, v63, v77
    v_perm_b32 v94, v63, v63, v78
    v_perm_b32 v95, v63, v63, v79
    v_mfma_f32_16x16x32_bf16 v[64:67], v[80:83], v[176:179], v[64:67]
    v_mfma_f32_16x16x32_bf16 v[64:67], v[84:87], v[180:183], v[64:67]
    v_mfma_f32_16x16x32_bf16 v[64:67], v[88:91], v[184:187], v[64:67]
    v_mfma_f32_16x16x32_bf16 v[64:67], v[92:95], v[188:191], v[64:67]
    s_waitcnt vmcnt(5)
    buffer_load_dwordx4 v[176:179], v3, s[12:15], s40 offen offset:0 nt
    s_waitcnt vmcnt(5)
    buffer_load_dwordx4 v[180:183], v3, s[12:15], s40 offen offset:256 nt
    s_waitcnt vmcnt(5)
    buffer_load_dwordx4 v[184:187], v3, s[12:15], s40 offen offset:512 nt
    s_waitcnt vmcnt(5)
    buffer_load_dwordx4 v[188:191], v3, s[12:15], s40 offen offset:768 nt
    s_add_u32 s50, s50, 1
    s_and_b32 s53, s50, 63
    s_and_b32 s41, s53, 1
    s_lshl_b32 s41, s41, 12
    s_xor_b32 s40, s49, s41
    s_and_b32 s41, s53, 2
    s_lshl_b32 s41, s41, 16
    s_xor_b32 s40, s40, s41
    s_and_b32 s41, s53, 4
    s_lshl_b32 s41, s41, 14
    s_xor_b32 s40, s40, s41
    s_and_b32 s41, s53, 24
    s_lshl_b32 s41, s41, 15
    s_xor_b32 s40, s40, s41
    s_and_b32 s41, s53, 16
    s_lshl_b32 s41, s41, 10
    s_xor_b32 s40, s40, s41
    s_and_b32 s41, s53, 32
    s_lshl_b32 s41, s41, 9
    s_xor_b32 s40, s40, s41
    s_sub_u32 s44, s44, 1
    s_cmp_eq_u32 s44, 0
    s_cbranch_scc1 L_v_end
    s_waitcnt lgkmcnt(0)
    v_readfirstlane_b32 s43, v31
    v_readfirstlane_b32 s45, v30
    s_nop 0
    s_sub_i32 s45, s45, s51
    s_add_u32 s51, s51, 8
    s_cmp_ge_i32 s45, 3
    s_addc_u32 s43, s43, 0
    s_cmp_le_i32 s45, 0
    s_subb_u32 s43, s43, 0
    s_cmp_eq_u32 s43, 0
    s_cbranch_scc1 L_v0
    s_cmp_eq_u32 s43, 1
    s_cbranch_scc1 L_v1
    s_cmp_eq_u32 s43, 2
    s_cbranch_scc1 L_v2
    s_cmp_eq_u32 s43, 3
    s_cbranch_scc1 L_v3
    s_cmp_eq_u32 s43, 4
    s_cbranch_scc1 L_v4
    s_cmp_eq_u32 s43, 5
    s_cbranch_scc1 L_v5
    s_branch L_v6
L_v5:
    s_waitcnt lgkmcnt(0)
    ds_read2_b64 v[60:63], v26 offset0:8 offset1:12
    v_add_u32 v26, 64, v26
    s_mov_b64 exec, 1
    ds_add_u32 v70, v71 offset:2496
    s_mov_b64 exec, -1
    v_perm_b32 v80, v32, v32, v72
    v_perm_b32 v81, v32, v32, v73
    v_perm_b32 v82, v32, v32, v74
    v_perm_b32 v83, v32, v32, v75
    v_perm_b32 v84, v32, v32, v76
    v_perm_b32 v85, v32, v32, v77
    v_perm_b32 v86, v32, v32, v78
    v_perm_b32 v87, v32, v32, v79
    v_perm_b32 v88, v33, v33, v72
    v_perm_b32 v89, v33, v33, v73
    v_perm_b32 v90, v33, v33, v74
    v_perm_b32 v91, v33, v33, v75
    v_perm_b32 v92, v33, v33, v76
    v_perm_b32 v93, v33, v33, v77
    v_perm_b32 v94, v33, v33, v78
    v_perm_b32 v95, v33, v33, v79
    v_mfma_f32_16x16x32_bf16 v[64:67], v[80:83], v[96:99], v[64:67]
    v_mfma_f32_16x16x32_bf16 v[64:67], v[84:87], v[100:103], v[64:67]
    v_mfma_f32_16x16x32_bf16 v[64:67], v[88:91], v[104:107], v[64:67]
    v_mfma_f32_16x16x32_bf16 v[64:67], v[92:95], v[108:111], v[64:67]
    s_waitcnt vmcnt(6)
    buffer_load_dwordx4 v[96:99], v3, s[12:15], s40 offen offset:0 nt
    s_waitcnt vmcnt(6)
    buffer_load_dwordx4 v[100:103], v3, s[12:15], s40 offen offset:256 nt
    s_waitcnt vmcnt(6)
    buffer_load_dwordx4 v[104:107], v3, s[12:15], s40 offen offset:512 nt
    s_waitcnt vmcnt(6)
    buffer_load_dwordx4 v[108:111], v3, s[12:15], s40 offen offset:768 nt
    s_add_u32 s50, s50, 1
    s_and_b32 s53, s50, 63
    s_and_b32 s41, s53, 1
    s_lshl_b32 s41, s41, 12
    s_xor_b32 s40, s49, s41
    s_and_b32 s41, s53, 2
    s_lshl_b32 s41, s41, 16
    s_xor_b32 s40, s40, s41
    s_and_b32 s41, s53, 4
    s_lshl_b32 s41, s41, 14
    s_xor_b32 s40, s40, s41
    s_and_b32 s41, s53, 24
    s_lshl_b32 s41, s41, 15
    s_xor_b32 s40, s40, s41
    s_and_b32 s41, s53, 16
    s_lshl_b32 s41, s41, 10
    s_xor_b32 s40, s40, s41
    s_and_b32 s41, s53, 32
    s_lshl_b32 s41, s41, 9
    s_xor_b32 s40, s40, s41
    v_perm_b32 v80, v34, v34, v72
    v_perm_b32 v81, v34, v34, v73
    v_perm_b32 v82, v34, v34, v74
    v_perm_b32 v83, v34, v34, v75
    v_perm_b32 v84, v34, v34, v76
    v_perm_b32 v85, v34, v34, v77
    v_perm_b32 v86, v34, v34, v78
    v_perm_b32 v87, v34, v34, v79
    v_perm_b32 v88, v35, v35, v72
    v_perm_b32 v89, v35, v35, v73
    v_perm_b32 v90, v35, v35, v74
    v_perm_b32 v91, v35, v35, v75
    v_perm_b32 v92, v35, v35, v76
    v_perm_b32 v93, v35, v35, v77
    v_perm_b32 v94, v35, v35, v78
    v_perm_b32 v95, v35, v35, v79
    v_mfma_f32_16x16x32_bf16 v[64:67], v[80:83], v[112:115], v[64:67]
    v_mfma_f32_16x16x32_bf16 v[64:67], v[84:87], v[116:119], v[64:67]
    v_mfma_f32_16x16x32_bf16 v[64:67], v[88:91], v[120:123], v[64:67]
    v_mfma_f32_16x16x32_bf16 v[64:67], v[92:95], v[124:127], v[64:67]
    s_waitcnt vmcnt(6)
    buffer_load_dwordx4 v[112:115], v3, s[12:15], s40 offen offset:0 nt
    s_waitcnt vmcnt(6)
    buffer_load_dwordx4 v[116:119], v3, s[12:15], s40 offen offset:256 nt
    s_waitcnt vmcnt(6)
    buffer_load_dwordx4 v[120:123], v3, s[12:15], s40 offen offset:512 nt
    s_waitcnt vmcnt(6)
    buffer_load_dwordx4 v[124:127], v3, s[12:15], s40 offen offset:768 nt
    s_add_u32 s50, s50, 1
    s_and_b32 s53, s50, 63
    s_and_b32 s41, s53, 1
    s_lshl_b32 s41, s41, 12
    s_xor_b32 s40, s49, s41
    s_and_b32 s41, s53, 2
    s_lshl_b32 s41, s41, 16
    s_xor_b32 s40, s40, s41
    s_and_b32 s41, s53, 4
    s_lshl_b32 s41, s41, 14
    s_xor_b32 s40, s40, s41
    s_and_b32 s41, s53, 24
    s_lshl_b32 s41, s41, 15
    s_xor_b32 s40, s40, s41
    s_and_b32 s41, s53, 16
    s_lshl_b32 s41, s41, 10
    s_xor_b32 s40, s40, s41
    s_and_b32 s41, s53, 32
    s_lshl_b32 s41, s41, 9
    s_xor_b32 s40, s40, s41
    s_waitcnt lgkmcnt(0)
    ds_read2_b64 v[32:35], v26 offset0:8 offset1:12
    v_add_u32 v26, 64, v26
    s_mov_b64 exec, 1
    ds_add_rtn_u32 v30, v70, v71 offset:2496
    s_mov_b64 exec, -1
    ds_read_b32 v31, v70 offset:2500
    v_perm_b32 v80, v60, v60, v72
    v_perm_b32 v81, v60, v60, v73
    v_perm_b32 v82, v60, v60, v74
    v_perm_b32 v83, v60, v60, v75
    v_perm_b32 v84, v60, v60, v76
    v_perm_b32 v85, v60, v60, v77
    v_perm_b32 v86, v60, v60, v78
    v_perm_b32 v87, v60, v60, v79
    v_perm_b32 v88, v61, v61, v72
    v_perm_b32 v89, v61, v61, v73
    v_perm_b32 v90, v61, v61, v74
    v_perm_b32 v91, v61, v61, v75
    v_perm_b32 v92, v61, v61, v76
    v_perm_b32 v93, v61, v61, v77
    v_perm_b32 v94, v61, v61, v78
    v_perm_b32 v95, v61, v61, v79
    v_mfma_f32_16x16x32_bf16 v[64:67], v[80:83], v[160:163], v[64:67]
    v_mfma_f32_16x16x32_bf16 v[64:67], v[84:87], v[164:167], v[64:67]
    v_mfma_f32_16x16x32_bf16 v[64:67], v[88:91], v[168:171], v[64:67]
    v_mfma_f32_16x16x32_bf16 v[64:67], v[92:95], v[172:175], v[64:67]
    s_waitcnt vmcnt(6)
    buffer_load_dwordx4 v[160:163], v3, s[12:15], s40 offen offset:0 nt
    s_waitcnt vmcnt(6)
    buffer_load_dwordx4 v[164:167], v3, s[12:15], s40 offen offset:256 nt
    s_waitcnt vmcnt(6)
    buffer_load_dwordx4 v[168:171], v3, s[12:15], s40 offen offset:512 nt
    s_waitcnt vmcnt(6)
    buffer_load_dwordx4 v[172:175], v3, s[12:15], s40 offen offset:768 nt
    s_add_u32 s50, s50, 1
    s_and_b32 s53, s50, 63
    s_and_b32 s41, s53, 1
    s_lshl_b32 s41, s41, 12
    s_xor_b32 s40, s49, s41
    s_and_b32 s41, s53, 2
    s_lshl_b32 s41, s41, 16
    s_xor_b32 s40, s40, s41
    s_and_b32 s41, s53, 4
    s_lshl_b32 s41, s41, 14
    s_xor_b32 s40, s40, s41
    s_and_b32 s41, s53, 24
    s_lshl_b32 s41, s41, 15
    s_xor_b32 s40, s40, s41
    s_and_b32 s41, s53, 16
    s_lshl_b32 s41, s41, 10
    s_xor_b32 s40, s40, s41
    s_and_b32 s41, s53, 32
    s_lshl_b32 s41, s41, 9
    s_xor_b32 s40, s40, s41
    v_perm_b32 v80, v62, v62, v72
    v_perm_b32 v81, v62, v62, v73
    v_perm_b32 v82, v62, v62, v74
    v_perm_b32 v83, v62, v62, v75
    v_perm_b32 v84, v62, v62, v76
    v_perm_b32 v85, v62, v62, v77
    v_perm_b32 v86, v62, v62, v78
    v_perm_b32 v87, v62, v62, v79
    v_perm_b32 v88, v63, v63, v72
    v_perm_b32 v89, v63, v63, v73
    v_perm_b32 v90, v63, v63, v74
    v_perm_b32 v91, v63, v63, v75
    v_perm_b32 v92, v63, v63, v76
    v_perm_b32 v93, v63, v63, v77
    v_perm_b32 v94, v63, v63, v78
    v_perm_b32 v95, v63, v63, v79
    v_mfma_f32_16x16x32_bf16 v[64:67], v[80:83], v[176:179], v[64:67]
    v_mfma_f32_16x16x32_bf16 v[64:67], v[84:87], v[180:183], v[64:67]
    v_mfma_f32_16x16x32_bf16 v[64:67], v[88:91], v[184:187], v[64:67]
    v_mfma_f32_16x16x32_bf16 v[64:67], v[92:95], v[188:191], v[64:67]
    s_waitcnt vmcnt(6)
    buffer_load_dwordx4 v[176:179], v3, s[12:15], s40 offen offset:0 nt
    s_waitcnt vmcnt(6)
    buffer_load_dwordx4 v[180:183], v3, s[12:15], s40 offen offset:256 nt
    s_waitcnt vmcnt(6)
    buffer_load_dwordx4 v[184:187], v3, s[12:15], s40 offen offset:512 nt
    s_waitcnt vmcnt(6)
    buffer_load_dwordx4 v[188:191], v3, s[12:15], s40 offen offset:768 nt
    s_add_u32 s50, s50, 1
    s_and_b32 s53, s50, 63
    s_and_b32 s41, s53, 1
    s_lshl_b32 s41, s41, 12
    s_xor_b32 s40, s49, s41
    s_and_b32 s41, s53, 2
    s_lshl_b32 s41, s41, 16
    s_xor_b32 s40, s40, s41
    s_and_b32 s41, s53, 4
    s_lshl_b32 s41, s41, 14
    s_xor_b32 s40, s40, s41
    s_and_b32 s41, s53, 24
    s_lshl_b32 s41, s41, 15
    s_xor_b32 s40, s40, s41
    s_and_b32 s41, s53, 16
    s_lshl_b32 s41, s41, 10
    s_xor_b32 s40, s40, s41
    s_and_b32 s41, s53, 32
    s_lshl_b32 s41, s41, 9
    s_xor_b32 s40, s40, s41
    s_sub_u32 s44, s44, 1
    s_cmp_eq_u32 s44, 0
    s_cbranch_scc1 L_v_end
    s_waitcnt lgkmcnt(0)
    v_readfirstlane_b32 s43, v31
    v_readfirstlane_b32 s45, v30
    s_nop 0
    s_sub_i32 s45, s45, s51
    s_add_u32 s51, s51, 8
    s_cmp_ge_i32 s45, 3
    s_addc_u32 s43, s43, 0
    s_cmp_le_i32 s45, 0
    s_subb_u32 s43, s43, 0
    s_cmp_eq_u32 s43, 0
    s_cbranch_scc1 L_v0
    s_cmp_eq_u32 s43, 1
    s_cbranch_scc1 L_v1
    s_cmp_eq_u32 s43, 2
    s_cbranch_scc1 L_v2
    s_cmp_eq_u32 s43, 3
    s_cbranch_scc1 L_v3
    s_cmp_eq_u32 s43, 4
    s_cbranch_scc1 L_v4
    s_cmp_eq_u32 s43, 5
    s_cbranch_scc1 L_v5
    s_branch L_v6
L_v6:
    s_waitcnt lgkmcnt(0)
    ds_read2_b64 v[60:63], v26 offset0:8 offset1:12
    v_add_u32 v26, 64, v26
    s_mov_b64 exec, 1
    ds_add_u32 v70, v71 offset:2496
    s_mov_b64 exec, -1
    v_perm_b32 v80, v32, v32, v72
    v_perm_b32 v81, v32, v32, v73
    v_perm_b32 v82, v32, v32, v74
    v_perm_b32 v83, v32, v32, v75
    v_perm_b32 v84, v32, v32, v76
    v_perm_b32 v85, v32, v32, v77
    v_perm_b32 v86, v32, v32, v78
    v_perm_b32 v87, v32, v32, v79
    v_perm_b32 v88, v33, v33, v72
    v_perm_b32 v89, v33, v33, v73
    v_perm_b32 v90, v33, v33, v74
    v_perm_b32 v91, v33, v33, v75
    v_perm_b32 v92, v33, v33, v76
    v_perm_b32 v93, v33, v33, v77
    v_perm_b32 v94, v33, v33, v78
    v_perm_b32 v95, v33, v33, v79
    v_mfma_f32_16x16x32_bf16 v[64:67], v[80:83], v[96:99], v[64:67]
    v_mfma_f32_16x16x32_bf16 v[64:67], v[84:87], v[100:103], v[64:67]
    v_mfma_f32_16x16x32_bf16 v[64:67], v[88:91], v[104:107], v[64:67]
    v_mfma_f32_16x16x32_bf16 v[64:67], v[92:95], v[108:111], v[64:67]
    buffer_load_dwordx4 v[96:99], v3, s[12:15], s40 offen offset:0 nt
    s_waitcnt vmcnt(7)
    buffer_load_dwordx4 v[100:103], v3, s[12:15], s40 offen offset:256 nt
    s_waitcnt vmcnt(7)
    buffer_load_dwordx4 v[104:107], v3, s[12:15], s40 offen offset:512 nt
    s_waitcnt vmcnt(7)
    buffer_load_dwordx4 v[108:111], v3, s[12:15], s40 offen offset:768 nt
    s_add_u32 s50, s50, 1
    s_and_b32 s53, s50, 63
    s_and_b32 s41, s53, 1
    s_lshl_b32 s41, s41, 12
    s_xor_b32 s40, s49, s41
    s_and_b32 s41, s53, 2
    s_lshl_b32 s41, s41, 16
    s_xor_b32 s40, s40, s41
    s_and_b32 s41, s53, 4
    s_lshl_b32 s41, s41, 14
    s_xor_b32 s40, s40, s41
    s_and_b32 s41, s53, 24
    s_lshl_b32 s41, s41, 15
    s_xor_b32 s40, s40, s41
    s_and_b32 s41, s53, 16
    s_lshl_b32 s41, s41, 10
    s_xor_b32 s40, s40, s41
    s_and_b32 s41, s53, 32
    s_lshl_b32 s41, s41, 9
    s_xor_b32 s40, s40, s41
    v_perm_b32 v80, v34, v34, v72
    v_perm_b32 v81, v34, v34, v73
    v_perm_b32 v82, v34, v34, v74
    v_perm_b32 v83, v34, v34, v75
    v_perm_b32 v84, v34, v34, v76
    v_perm_b32 v85, v34, v34, v77
    v_perm_b32 v86, v34, v34, v78
    v_perm_b32 v87, v34, v34, v79
    v_perm_b32 v88, v35, v35, v72
    v_perm_b32 v89, v35, v35, v73
    v_perm_b32 v90, v35, v35, v74
    v_perm_b32 v91, v35, v35, v75
    v_perm_b32 v92, v35, v35, v76
    v_perm_b32 v93, v35, v35, v77
    v_perm_b32 v94, v35, v35, v78
    v_perm_b32 v95, v35, v35, v79
    v_mfma_f32_16x16x32_bf16 v[64:67], v[80:83], v[112:115], v[64:67]
    v_mfma_f32_16x16x32_bf16 v[64:67], v[84:87], v[116:119], v[64:67]
    v_mfma_f32_16x16x32_bf16 v[64:67], v[88:91], v[120:123], v[64:67]
    v_mfma_f32_16x16x32_bf16 v[64:67], v[92:95], v[124:127], v[64:67]
    s_waitcnt vmcnt(7)
    buffer_load_dwordx4 v[112:115], v3, s[12:15], s40 offen offset:0 nt
    s_waitcnt vmcnt(7)
    buffer_load_dwordx4 v[116:119], v3, s[12:15], s40 offen offset:256 nt
    s_waitcnt vmcnt(7)
    buffer_load_dwordx4 v[120:123], v3, s[12:15], s40 offen offset:512 nt
    s_waitcnt vmcnt(7)
    buffer_load_dwordx4 v[124:127], v3, s[12:15], s40 offen offset:768 nt
    s_add_u32 s50, s50, 1
    s_and_b32 s53, s50, 63
    s_and_b32 s41, s53, 1
    s_lshl_b32 s41, s41, 12
    s_xor_b32 s40, s49, s41
    s_and_b32 s41, s53, 2
    s_lshl_b32 s41, s41, 16
    s_xor_b32 s40, s40, s41
    s_and_b32 s41, s53, 4
    s_lshl_b32 s41, s41, 14
    s_xor_b32 s40, s40, s41
    s_and_b32 s41, s53, 24
    s_lshl_b32 s41, s41, 15
    s_xor_b32 s40, s40, s41
    s_and_b32 s41, s53, 16
    s_lshl_b32 s41, s41, 10
    s_xor_b32 s40, s40, s41
    s_and_b32 s41, s53, 32
    s_lshl_b32 s41, s41, 9
    s_xor_b32 s40, s40, s41
    s_waitcnt lgkmcnt(0)
    ds_read2_b64 v[32:35], v26 offset0:8 offset1:12
    v_add_u32 v26, 64, v26
    s_mov_b64 exec, 1
    ds_add_rtn_u32 v30, v70, v71 offset:2496
    s_mov_b64 exec, -1
    ds_read_b32 v31, v70 offset:2500
    v_perm_b32 v80, v60, v60, v72
    v_perm_b32 v81, v60, v60, v73
    v_perm_b32 v82, v60, v60, v74
    v_perm_b32 v83, v60, v60, v75
    v_perm_b32 v84, v60, v60, v76
    v_perm_b32 v85, v60, v60, v77
    v_perm_b32 v86, v60, v60, v78
    v_perm_b32 v87, v60, v60, v79
    v_perm_b32 v88, v61, v61, v72
    v_perm_b32 v89, v61, v61, v73
    v_perm_b32 v90, v61, v61, v74
    v_perm_b32 v91, v61, v61, v75
    v_perm_b32 v92, v61, v61, v76
    v_perm_b32 v93, v61, v61, v77
    v_perm_b32 v94, v61, v61, v78
    v_perm_b32 v95, v61, v61, v79
    v_mfma_f32_16x16x32_bf16 v[64:67], v[80:83], v[160:163], v[64:67]
    v_mfma_f32_16x16x32_bf16 v[64:67], v[84:87], v[164:167], v[64:67]
    v_mfma_f32_16x16x32_bf16 v[64:67], v[88:91], v[168:171], v[64:67]
    v_mfma_f32_16x16x32_bf16 v[64:67], v[92:95], v[172:175], v[64:67]
    s_waitcnt vmcnt(7)
    buffer_load_dwordx4 v[160:163], v3, s[12:15], s40 offen offset:0 nt
    s_waitcnt vmcnt(7)
    buffer_load_dwordx4 v[164:167], v3, s[12:15], s40 offen offset:256 nt
    s_waitcnt vmcnt(7)
    buffer_load_dwordx4 v[168:171], v3, s[12:15], s40 offen offset:512 nt
    s_waitcnt vmcnt(7)
    buffer_load_dwordx4 v[172:175], v3, s[12:15], s40 offen offset:768 nt
    s_add_u32 s50, s50, 1
    s_and_b32 s53, s50, 63
    s_and_b32 s41, s53, 1
    s_lshl_b32 s41, s41, 12
    s_xor_b32 s40, s49, s41
    s_and_b32 s41, s53, 2
    s_lshl_b32 s41, s41, 16
    s_xor_b32 s40, s40, s41
    s_and_b32 s41, s53, 4
    s_lshl_b32 s41, s41, 14
    s_xor_b32 s40, s40, s41
    s_and_b32 s41, s53, 24
    s_lshl_b32 s41, s41, 15
    s_xor_b32 s40, s40, s41
    s_and_b32 s41, s53, 16
    s_lshl_b32 s41, s41, 10
    s_xor_b32 s40, s40, s41
    s_and_b32 s41, s53, 32
    s_lshl_b32 s41, s41, 9
    s_xor_b32 s40, s40, s41
    v_perm_b32 v80, v62, v62, v72
    v_perm_b32 v81, v62, v62, v73
    v_perm_b32 v82, v62, v62, v74
    v_perm_b32 v83, v62, v62, v75
    v_perm_b32 v84, v62, v62, v76
    v_perm_b32 v85, v62, v62, v77
    v_perm_b32 v86, v62, v62, v78
    v_perm_b32 v87, v62, v62, v79
    v_perm_b32 v88, v63, v63, v72
    v_perm_b32 v89, v63, v63, v73
    v_perm_b32 v90, v63, v63, v74
    v_perm_b32 v91, v63, v63, v75
    v_perm_b32 v92, v63, v63, v76
    v_perm_b32 v93, v63, v63, v77
    v_perm_b32 v94, v63, v63, v78
    v_perm_b32 v95, v63, v63, v79
    v_mfma_f32_16x16x32_bf16 v[64:67], v[80:83], v[176:179], v[64:67]
    v_mfma_f32_16x16x32_bf16 v[64:67], v[84:87], v[180:183], v[64:67]
    v_mfma_f32_16x16x32_bf16 v[64:67], v[88:91], v[184:187], v[64:67]
    v_mfma_f32_16x16x32_bf16 v[64:67], v[92:95], v[188:191], v[64:67]
    s_waitcnt vmcnt(7)
    buffer_load_dwordx4 v[176:179], v3, s[12:15], s40 offen offset:0 nt
    s_waitcnt vmcnt(7)
    buffer_load_dwordx4 v[180:183], v3, s[12:15], s40 offen offset:256 nt
    s_waitcnt vmcnt(7)
    buffer_load_dwordx4 v[184:187], v3, s[12:15], s40 offen offset:512 nt
    s_waitcnt vmcnt(7)
    buffer_load_dwordx4 v[188:191], v3, s[12:15], s40 offen offset:768 nt
    s_add_u32 s50, s50, 1
    s_and_b32 s53, s50, 63
    s_and_b32 s41, s53, 1
    s_lshl_b32 s41, s41, 12
    s_xor_b32 s40, s49, s41
    s_and_b32 s41, s53, 2
    s_lshl_b32 s41, s41, 16
    s_xor_b32 s40, s40, s41
    s_and_b32 s41, s53, 4
    s_lshl_b32 s41, s41, 14
    s_xor_b32 s40, s40, s41
    s_and_b32 s41, s53, 24
    s_lshl_b32 s41, s41, 15
    s_xor_b32 s40, s40, s41
    s_and_b32 s41, s53, 16
    s_lshl_b32 s41, s41, 10
    s_xor_b32 s40, s40, s41
    s_and_b32 s41, s53, 32
    s_lshl_b32 s41, s41, 9
    s_xor_b32 s40, s40, s41
    s_sub_u32 s44, s44, 1
    s_cmp_eq_u32 s44, 0
    s_cbranch_scc1 L_v_end
    s_waitcnt lgkmcnt(0)
    v_readfirstlane_b32 s43, v31
    v_readfirstlane_b32 s45, v30
    s_nop 0
    s_sub_i32 s45, s45, s51
    s_add_u32 s51, s51, 8
    s_cmp_ge_i32 s45, 3
    s_addc_u32 s43, s43, 0
    s_cmp_le_i32 s45, 0
    s_subb_u32 s43, s43, 0
    s_cmp_eq_u32 s43, 0
    s_cbranch_scc1 L_v0
    s_cmp_eq_u32 s43, 1
    s_cbranch_scc1 L_v1
    s_cmp_eq_u32 s43, 2
    s_cbranch_scc1 L_v2
    s_cmp_eq_u32 s43, 3
    s_cbranch_scc1 L_v3
    s_cmp_eq_u32 s43, 4
    s_cbranch_scc1 L_v4
    s_cmp_eq_u32 s43, 5
    s_cbranch_scc1 L_v5
    s_branch L_v6
L_v_end:
    s_waitcnt lgkmcnt(0)
    ds_read2_b64 v[60:63], v26 offset0:8 offset1:12
    v_add_u32 v26, 64, v26
    s_mov_b64 exec, 1
    ds_add_u32 v70, v71 offset:2496
    s_mov_b64 exec, -1
    v_perm_b32 v80, v32, v32, v72
    v_perm_b32 v81, v32, v32, v73
    v_perm_b32 v82, v32, v32, v74
    v_perm_b32 v83, v32, v32, v75
    v_perm_b32 v84, v32, v32, v76
    v_perm_b32 v85, v32, v32, v77
    v_perm_b32 v86, v32, v32, v78
    v_perm_b32 v87, v32, v32, v79
    v_perm_b32 v88, v33, v33, v72
    v_perm_b32 v89, v33, v33, v73
    v_perm_b32 v90, v33, v33, v74
    v_perm_b32 v91, v33, v33, v75
    v_perm_b32 v92, v33, v33, v76
    v_perm_b32 v93, v33, v33, v77
    v_perm_b32 v94, v33, v33, v78
    v_perm_b32 v95, v33, v33, v79
    v_mfma_f32_16x16x32_bf16 v[64:67], v[80:83], v[96:99], v[64:67]
    v_mfma_f32_16x16x32_bf16 v[64:67], v[84:87], v[100:103], v[64:67]
    v_mfma_f32_16x16x32_bf16 v[64:67], v[88:91], v[104:107], v[64:67]
    v_mfma_f32_16x16x32_bf16 v[64:67], v[92:95], v[108:111], v[64:67]
    buffer_load_dwordx4 v[96:99], v3, s[12:15], s40 offen offset:0 nt
    s_waitcnt vmcnt(7)
    buffer_load_dwordx4 v[100:103], v3, s[12:15], s40 offen offset:256 nt
    s_waitcnt vmcnt(7)
    buffer_load_dwordx4 v[104:107], v3, s[12:15], s40 offen offset:512 nt
    s_waitcnt vmcnt(7)
    buffer_load_dwordx4 v[108:111], v3, s[12:15], s40 offen offset:768 nt
    s_add_u32 s50, s50, 1
    s_and_b32 s53, s50, 63
    s_and_b32 s41, s53, 1
    s_lshl_b32 s41, s41, 12
    s_xor_b32 s40, s49, s41
    s_and_b32 s41, s53, 2
    s_lshl_b32 s41, s41, 16
    s_xor_b32 s40, s40, s41
    s_and_b32 s41, s53, 4
    s_lshl_b32 s41, s41, 14
    s_xor_b32 s40, s40, s41
    s_and_b32 s41, s53, 24
    s_lshl_b32 s41, s41, 15
    s_xor_b32 s40, s40, s41
    s_and_b32 s41, s53, 16
    s_lshl_b32 s41, s41, 10
    s_xor_b32 s40, s40, s41
    s_and_b32 s41, s53, 32
    s_lshl_b32 s41, s41, 9
    s_xor_b32 s40, s40, s41
    v_perm_b32 v80, v34, v34, v72
    v_perm_b32 v81, v34, v34, v73
    v_perm_b32 v82, v34, v34, v74
    v_perm_b32 v83, v34, v34, v75
    v_perm_b32 v84, v34, v34, v76
    v_perm_b32 v85, v34, v34, v77
    v_perm_b32 v86, v34, v34, v78
    v_perm_b32 v87, v34, v34, v79
    v_perm_b32 v88, v35, v35, v72
    v_perm_b32 v89, v35, v35, v73
    v_perm_b32 v90, v35, v35, v74
    v_perm_b32 v91, v35, v35, v75
    v_perm_b32 v92, v35, v35, v76
    v_perm_b32 v93, v35, v35, v77
    v_perm_b32 v94, v35, v35, v78
    v_perm_b32 v95, v35, v35, v79
    v_mfma_f32_16x16x32_bf16 v[64:67], v[80:83], v[112:115], v[64:67]
    v_mfma_f32_16x16x32_bf16 v[64:67], v[84:87], v[116:119], v[64:67]
    v_mfma_f32_16x16x32_bf16 v[64:67], v[88:91], v[120:123], v[64:67]
    v_mfma_f32_16x16x32_bf16 v[64:67], v[92:95], v[124:127], v[64:67]
    s_waitcnt vmcnt(7)
    buffer_load_dwordx4 v[112:115], v3, s[12:15], s40 offen offset:0 nt
    s_waitcnt vmcnt(7)
    buffer_load_dwordx4 v[116:119], v3, s[12:15], s40 offen offset:256 nt
    s_waitcnt vmcnt(7)
    buffer_load_dwordx4 v[120:123], v3, s[12:15], s40 offen offset:512 nt
    s_waitcnt vmcnt(7)
    buffer_load_dwordx4 v[124:127], v3, s[12:15], s40 offen offset:768 nt
    s_add_u32 s50, s50, 1
    s_and_b32 s53, s50, 63
    s_and_b32 s41, s53, 1
    s_lshl_b32 s41, s41, 12
    s_xor_b32 s40, s49, s41
    s_and_b32 s41, s53, 2
    s_lshl_b32 s41, s41, 16
    s_xor_b32 s40, s40, s41
    s_and_b32 s41, s53, 4
    s_lshl_b32 s41, s41, 14
    s_xor_b32 s40, s40, s41
    s_and_b32 s41, s53, 24
    s_lshl_b32 s41, s41, 15
    s_xor_b32 s40, s40, s41
    s_and_b32 s41, s53, 16
    s_lshl_b32 s41, s41, 10
    s_xor_b32 s40, s40, s41
    s_and_b32 s41, s53, 32
    s_lshl_b32 s41, s41, 9
    s_xor_b32 s40, s40, s41
    s_waitcnt lgkmcnt(0)
    ds_read2_b64 v[32:35], v26 offset0:8 offset1:12
    v_add_u32 v26, 64, v26
    v_perm_b32 v80, v60, v60, v72
    v_perm_b32 v81, v60, v60, v73
    v_perm_b32 v82, v60, v60, v74
    v_perm_b32 v83, v60, v60, v75
    v_perm_b32 v84, v60, v60, v76
    v_perm_b32 v85, v60, v60, v77
    v_perm_b32 v86, v60, v60, v78
    v_perm_b32 v87, v60, v60, v79
    v_perm_b32 v88, v61, v61, v72
    v_perm_b32 v89, v61, v61, v73
    v_perm_b32 v90, v61, v61, v74
    v_perm_b32 v91, v61, v61, v75
    v_perm_b32 v92, v61, v61, v76
    v_perm_b32 v93, v61, v61, v77
    v_perm_b32 v94, v61, v61, v78
    v_perm_b32 v95, v61, v61, v79
    v_mfma_f32_16x16x32_bf16 v[64:67], v[80:83], v[160:163], v[64:67]
    v_mfma_f32_16x16x32_bf16 v[64:67], v[84:87], v[164:167], v[64:67]
    v_mfma_f32_16x16x32_bf16 v[64:67], v[88:91], v[168:171], v[64:67]
    v_mfma_f32_16x16x32_bf16 v[64:67], v[92:95], v[172:175], v[64:67]
    v_perm_b32 v80, v62, v62, v72
    v_perm_b32 v81, v62, v62, v73
    v_perm_b32 v82, v62, v62, v74
    v_perm_b32 v83, v62, v62, v75
    v_perm_b32 v84, v62, v62, v76
    v_perm_b32 v85, v62, v62, v77
    v_perm_b32 v86, v62, v62, v78
    v_perm_b32 v87, v62, v62, v79
    v_perm_b32 v88, v63, v63, v72
    v_perm_b32 v89, v63, v63, v73
    v_perm_b32 v90, v63, v63, v74
    v_perm_b32 v91, v63, v63, v75
    v_perm_b32 v92, v63, v63, v76
    v_perm_b32 v93, v63, v63, v77
    v_perm_b32 v94, v63, v63, v78
    v_perm_b32 v95, v63, v63, v79
    v_mfma_f32_16x16x32_bf16 v[64:67], v[80:83], v[176:179], v[64:67]
    v_mfma_f32_16x16x32_bf16 v[64:67], v[84:87], v[180:183], v[64:67]
    v_mfma_f32_16x16x32_bf16 v[64:67], v[88:91], v[184:187], v[64:67]
    v_mfma_f32_16x16x32_bf16 v[64:67], v[92:95], v[188:191], v[64:67]
    s_waitcnt lgkmcnt(0)
    ds_read2_b64 v[60:63], v26 offset0:8 offset1:12
    v_add_u32 v26, 64, v26
    v_perm_b32 v80, v32, v32, v72
    v_perm_b32 v81, v32, v32, v73
    v_perm_b32 v82, v32, v32, v74
    v_perm_b32 v83, v32, v32, v75
    v_perm_b32 v84, v32, v32, v76
    v_perm_b32 v85, v32, v32, v77
    v_perm_b32 v86, v32, v32, v78
    v_perm_b32 v87, v32, v32, v79
    v_perm_b32 v88, v33, v33, v72
    v_perm_b32 v89, v33, v33, v73
    v_perm_b32 v90, v33, v33, v74
    v_perm_b32 v91, v33, v33, v75
    v_perm_b32 v92, v33, v33, v76
    v_perm_b32 v93, v33, v33, v77
    v_perm_b32 v94, v33, v33, v78
    v_perm_b32 v95, v33, v33, v79
    s_waitcnt vmcnt(4)
    v_mfma_f32_16x16x32_bf16 v[64:67], v[80:83], v[96:99], v[64:67]
    v_mfma_f32_16x16x32_bf16 v[64:67], v[84:87], v[100:103], v[64:67]
    v_mfma_f32_16x16x32_bf16 v[64:67], v[88:91], v[104:107], v[64:67]
    v_mfma_f32_16x16x32_bf16 v[64:67], v[92:95], v[108:111], v[64:67]
    v_perm_b32 v80, v34, v34, v72
    v_perm_b32 v81, v34, v34, v73
    v_perm_b32 v82, v34, v34, v74
    v_perm_b32 v83, v34, v34, v75
    v_perm_b32 v84, v34, v34, v76
    v_perm_b32 v85, v34, v34, v77
    v_perm_b32 v86, v34, v34, v78
    v_perm_b32 v87, v34, v34, v79
    v_perm_b32 v88, v35, v35, v72
    v_perm_b32 v89, v35, v35, v73
    v_perm_b32 v90, v35, v35, v74
    v_perm_b32 v91, v35, v35, v75
    v_perm_b32 v92, v35, v35, v76
    v_perm_b32 v93, v35, v35, v77
    v_perm_b32 v94, v35, v35, v78
    v_perm_b32 v95, v35, v35, v79
    s_waitcnt vmcnt(0)
    v_mfma_f32_16x16x32_bf16 v[64:67], v[80:83], v[112:115], v[64:67]
    v_mfma_f32_16x16x32_bf16 v[64:67], v[84:87], v[116:119], v[64:67]
    v_mfma_f32_16x16x32_bf16 v[64:67], v[88:91], v[120:123], v[64:67]
    v_mfma_f32_16x16x32_bf16 v[64:67], v[92:95], v[124:127], v[64:67]
    s_mov_b32 exec_lo, -1
    s_mov_b32 exec_hi, 0
    s_nop 5
    ds_write_b128 v6, v[64:67] offset:256
    s_mov_b64 exec, -1
    s_waitcnt lgkmcnt(0)
    s_barrier
    s_cmp_lg_u32 s3, 0
    s_cbranch_scc1 L_fin
    ds_read_b32 v20, v13 offset:2368
    ds_read_b32 v21, v13 offset:2400
    ds_read_u16 v24, v14 offset:2504
    s_mov_b32 s45, 0x4000
    s_mov_b32 s46, 0x8000
    s_mov_b32 s47, 0xc000
    s_mov_b32 s48, 0xffffff00
    s_mov_b32 s49, 0x0c0c0400
    s_mov_b32 s50, 0xaaaaaaaa
    s_mov_b32 s51, 0xaaaaaaaa
    v_lshlrev_b32 v10, 16, v10
    v_lshlrev_b32 v11, 16, v11
    s_mov_b32 s44, 262144
L_fpoll:
    buffer_load_dwordx2 v[40:41], v12, s[96:99], 0 offen sc1
    buffer_load_dwordx2 v[42:43], v12, s[96:99], s45 offen sc1
    buffer_load_dwordx2 v[44:45], v12, s[96:99], s46 offen sc1
    buffer_load_dwordx2 v[46:47], v12, s[96:99], s47 offen sc1
    s_waitcnt vmcnt(0) lgkmcnt(0)
    v_perm_b32 v48, v41, v40, s49
    v_perm_b32 v49, v43, v42, s49
    v_perm_b32 v50, v45, v44, s49
    v_perm_b32 v51, v47, v46, s49
    v_xor_b32 v48, v48, v24
    v_xor_b32 v49, v49, v24
    v_xor_b32 v50, v50, v24
    v_xor_b32 v51, v51, v24
    v_or3_b32 v48, v48, v49, v50
    v_or_b32 v48, v48, v51
    v_cmp_ne_u32 vcc, 0, v48
    s_sub_u32 s44, s44, 1
    s_cbranch_vccz L_fgo
    s_cmp_lg_u32 s44, 0
    s_cbranch_scc1 L_fpoll
L_fgo:
    s_mov_b64 exec, -1
    v_and_b32 v40, s48, v40
    v_and_b32 v41, s48, v41
    v_and_b32 v42, s48, v42
    v_and_b32 v43, s48, v43
    v_and_b32 v44, s48, v44
    v_and_b32 v45, s48, v45
    v_and_b32 v46, s48, v46
    v_and_b32 v47, s48, v47
    v_add_f32 v40, v40, v42
    v_add_f32 v41, v41, v43
    v_add_f32 v44, v44, v46
    v_add_f32 v45, v45, v47
    v_add_f32 v40, v40, v44
    v_add_f32 v41, v41, v45
    s_nop 0
    v_add_f32_dpp v40, v40, v40 row_ror:8 row_mask:0xf bank_mask:0xf
    v_add_f32_dpp v41, v41, v41 row_ror:8 row_mask:0xf bank_mask:0xf
    v_mov_b32 v44, v40
    v_mov_b32 v45, v41
    s_nop 0
    v_permlane16_swap_b32 v40, v44
    v_permlane16_swap_b32 v41, v45
    v_add_f32 v40, v40, v44
    v_add_f32 v41, v41, v45
    v_mov_b32 v44, v40
    v_mov_b32 v45, v41
    s_nop 0
    v_permlane32_swap_b32 v40, v44
    v_permlane32_swap_b32 v41, v45
    v_add_f32 v40, v40, v44
    v_add_f32 v41, v41, v45
    v_cvt_pk_bf16_f32 v40, v40, v41
    v_and_b32 v41, s7, v40
    v_lshlrev_b32 v40, 16, v40
    v_mul_f32 v40, v40, v20
    v_mul_f32 v41, v41, v21
    v_cvt_pk_bf16_f32 v40, v40, v41
    v_and_b32 v41, s7, v40
    v_lshlrev_b32 v40, 16, v40
    v_add_f32 v40, v40, v10
    v_add_f32 v41, v41, v11
    s_nop 0
    v_mov_b32_dpp v42, v40 quad_perm:[1,1,3,3] row_mask:0xf bank_mask:0xf
    v_mov_b32_dpp v43, v41 quad_perm:[0,0,2,2] row_mask:0xf bank_mask:0xf
    v_cndmask_b32 v40, v40, v43, s[50:51]
    v_cndmask_b32 v41, v42, v41, s[50:51]
    v_cvt_pk_bf16_f32 v40, v40, v41
    s_mov_b64 exec, 0xff
    global_store_dword v25, v40, s[34:35]
    s_mov_b64 exec, -1
    s_endpgm
L_helper:
    s_setprio 2
    s_sub_u32 s45, s3, 4
    v_lshrrev_b32 v6, 5, v0
    v_and_b32 v7, 31, v0
    s_lshl_b32 s43, s45, 11
    v_lshlrev_b32 v8, 10, v6
    v_lshl_add_u32 v8, v7, 4, v8
    v_add_u32 v8, s43, v8
    s_lshr_b32 s43, s4, 2
    s_lshl_b32 s43, s43, 21
    s_lshl_b32 s46, s45, 19
    s_add_u32 s43, s43, s46
    s_lshl_b32 s46, s5, 8
    s_add_u32 s43, s43, s46
    s_and_b32 s46, s4, 3
    s_lshl_b32 s46, s46, 6
    s_add_u32 s43, s43, s46
    v_lshrrev_b32 v9, 2, v0
    v_lshlrev_b32 v2, 13, v9
    v_and_b32 v10, 3, v0
    v_lshl_add_u32 v2, v10, 4, v2
    v_add_u32 v2, s43, v2
    s_lshl_b32 s47, s45, 12
    s_add_u32 s47, s47, 30464
    s_mov_b32 s10, 0x400000
    s_mov_b32 s11, 0x20000
    s_mov_b32 m0, s47
    s_waitcnt lgkmcnt(0)
    global_load_dwordx4 v[96:99], v8, s[16:17] nt
    global_load_dwordx4 v[100:103], v8, s[16:17] offset:512 nt
    s_mov_b32 s8, s22
    s_mov_b32 s9, s23
    s_load_dwordx2 s[52:53], s[38:39], 0
    s_add_u32 m0, s47, 0
    s_mov_b32 s40, 0
    buffer_load_dwordx4 v2, s[8:11], s40 offen nt lds
    s_add_u32 m0, s47, 1024
    s_mov_b32 s40, 131072
    buffer_load_dwordx4 v2, s[8:11], s40 offen nt lds
    s_mov_b32 s96, s38
    s_mov_b32 s97, s39
    s_lshl_b32 s43, s45, 1
    v_add_u32 v6, s43, v6
    v_mul_u32_u24 v11, 1040, v6
    v_lshl_add_u32 v11, v7, 4, v11
    v_lshrrev_b32 v6, 2, v4
    v_and_b32 v7, 3, v4
    v_lshlrev_b32 v13, 10, v5
    v_lshl_add_u32 v13, v6, 7, v13
    v_lshl_add_u32 v13, v7, 3, v13
    v_lshlrev_b32 v15, 11, v5
    v_lshl_add_u32 v15, v6, 8, v15
    v_lshl_add_u32 v15, v7, 3, v15
    v_and_b32 v6, 7, v4
    v_mul_u32_u24 v14, 1040, v6
    v_lshl_add_u32 v14, v5, 4, v14
    v_lshrrev_b32 v26, 2, v4
    v_lshlrev_b32 v26, 6, v26
    v_lshl_add_u32 v26, v5, 9, v26
    v_lshl_add_u32 v26, v7, 3, v26
    s_lshr_b32 s43, s4, 2
    s_lshl_b32 s43, s43, 9
    v_add_u32 v27, s43, v14
    s_lshl_b32 s93, s5, 13
    s_add_u32 s93, s93, 262144
    s_lshl_b32 s46, s4, 10
    s_add_u32 s43, s93, s46
    v_lshlrev_b32 v28, 7, v6
    v_lshl_add_u32 v28, v5, 4, v28
    v_add_u32 v28, s43, v28
    v_lshrrev_b32 v8, 3, v4
    v_lshl_add_u32 v28, v8, 6, v28
    s_lshl_b32 s46, s45, 10
    s_add_u32 s93, s93, s46
    s_lshl_b32 s46, s4, 7
    s_add_u32 s93, s93, s46
    s_lshl_b32 s43, s45, 6
    v_lshl_add_u32 v12, v0, 1, s43
    s_lshl_b32 s43, s45, 2
    v_mov_b32 v30, s43
    v_mov_b32 v29, 1
    v_and_b32 v31, 3, v0
    v_lshlrev_b32 v31, 2, v31
    s_mul_i32 s95, s2, 57
    s_lshr_b32 s95, s95, 9
    s_mul_i32 s43, s95, 9
    s_cmp_lg_u32 s43, s2
    s_cselect_b32 s95, 28, s95
    s_cmp_lt_u32 s95, 28
    s_cselect_b32 s43, 3, 2
    v_mov_b32 v39, 0
    v_mov_b32 v38, 0
    v_mov_b32 v40, s43
    ds_write_b32 v39, v39 offset:2496
    ds_write_b32 v39, v40 offset:2500
    v_mov_b32 v41, 0
    v_lshlrev_b32 v42, 2, v4
    ds_write_b32 v42, v41 offset:2432
    ds_write_b32 v42, v41 offset:2304
    s_waitcnt lgkmcnt(0)
    s_barrier
    s_waitcnt vmcnt(2)
    s_add_u32 s52, s52, 1
    s_addc_u32 s53, s53, 0
    v_mov_b32 v24, s52
    v_mov_b32 v25, s53
    s_mul_i32 s90, s52, 0x9e3779b1
    s_xor_b32 s90, s90, s53
    s_mul_i32 s91, s52, 0x85ebca77
    s_add_u32 s91, s91, s53
    v_mov_b32 v40, s90
    v_mov_b32 v41, s91
    ds_write_b64 v39, v[40:41] offset:2504
    v_lshlrev_b32 v104, 16, v96
    v_and_b32 v105, s7, v96
    v_lshlrev_b32 v106, 16, v97
    v_and_b32 v107, s7, v97
    v_lshlrev_b32 v108, 16, v98
    v_and_b32 v109, s7, v98
    v_lshlrev_b32 v110, 16, v99
    v_and_b32 v111, s7, v99
    v_lshlrev_b32 v112, 16, v100
    v_and_b32 v113, s7, v100
    v_lshlrev_b32 v114, 16, v101
    v_and_b32 v115, s7, v101
    v_lshlrev_b32 v116, 16, v102
    v_and_b32 v117, s7, v102
    v_lshlrev_b32 v118, 16, v103
    v_and_b32 v119, s7, v103
    v_add_f32 v40, v104, v105
    v_add_f32 v41, v106, v107
    v_add_f32 v40, v40, v108
    v_add_f32 v41, v41, v109
    v_add_f32 v40, v40, v110
    v_add_f32 v41, v41, v111
    v_add_f32 v40, v40, v112
    v_add_f32 v41, v41, v113
    v_add_f32 v40, v40, v114
    v_add_f32 v41, v41, v115
    v_add_f32 v40, v40, v116
    v_add_f32 v41, v41, v117
    v_add_f32 v40, v40, v118
    v_add_f32 v41, v41, v119
    v_add_f32 v40, v40, v41
    s_nop 1
    v_add_f32_dpp v40, v40, v40 quad_perm:[1,0,3,2] row_mask:0xf bank_mask:0xf
    s_nop 1
    v_add_f32_dpp v40, v40, v40 quad_perm:[2,3,0,1] row_mask:0xf bank_mask:0xf
    s_nop 1
    v_add_f32_dpp v40, v40, v40 row_half_mirror row_mask:0xf bank_mask:0xf
    s_nop 1
    v_add_f32_dpp v40, v40, v40 row_mirror row_mask:0xf bank_mask:0xf
    v_mov_b32 v47, v40
    s_nop 1
    v_permlane16_swap_b32 v40, v47
    v_add_f32 v40, v40, v47
    v_mul_f32 v40, 0x3b000000, v40
    v_sub_f32 v43, v104, v40
    v_sub_f32 v44, v105, v40
    v_mul_f32 v41, v43, v43
    v_mul_f32 v42, v44, v44
    v_sub_f32 v43, v106, v40
    v_sub_f32 v44, v107, v40
    v_fmac_f32 v41, v43, v43
    v_fmac_f32 v42, v44, v44
    v_sub_f32 v43, v108, v40
    v_sub_f32 v44, v109, v40
    v_fmac_f32 v41, v43, v43
    v_fmac_f32 v42, v44, v44
    v_sub_f32 v43, v110, v40
    v_sub_f32 v44, v111, v40
    v_fmac_f32 v41, v43, v43
    v_fmac_f32 v42, v44, v44
    v_sub_f32 v43, v112, v40
    v_sub_f32 v44, v113, v40
    v_fmac_f32 v41, v43, v43
    v_fmac_f32 v42, v44, v44
    v_sub_f32 v43, v114, v40
    v_sub_f32 v44, v115, v40
    v_fmac_f32 v41, v43, v43
    v_fmac_f32 v42, v44, v44
    v_sub_f32 v43, v116, v40
    v_sub_f32 v44, v117, v40
    v_fmac_f32 v41, v43, v43
    v_fmac_f32 v42, v44, v44
    v_sub_f32 v43, v118, v40
    v_sub_f32 v44, v119, v40
    v_fmac_f32 v41, v43, v43
    v_fmac_f32 v42, v44, v44
    v_add_f32 v41, v41, v42
    s_nop 1
    v_add_f32_dpp v41, v41, v41 quad_perm:[1,0,3,2] row_mask:0xf bank_mask:0xf
    s_nop 1
    v_add_f32_dpp v41, v41, v41 quad_perm:[2,3,0,1] row_mask:0xf bank_mask:0xf
    s_nop 1
    v_add_f32_dpp v41, v41, v41 row_half_mirror row_mask:0xf bank_mask:0xf
    s_nop 1
    v_add_f32_dpp v41, v41, v41 row_mirror row_mask:0xf bank_mask:0xf
    v_mov_b32 v47, v41
    s_nop 1
    v_permlane16_swap_b32 v41, v47
    v_add_f32 v41, v41, v47
    v_mul_f32 v41, 0x3b000000, v41
    v_cvt_pk_bf16_f32 v41, v41, v41
    v_and_b32 v41, s7, v41
    v_cvt_pk_bf16_f32 v40, v40, v40
    v_and_b32 v40, s7, v40
    v_add_f32 v41, 0x3727c5ac, v41
    v_cvt_pk_bf16_f32 v41, v41, v41
    v_and_b32 v41, s7, v41
    v_sqrt_f32 v41, v41
    s_nop 0
    v_cvt_pk_bf16_f32 v41, v41, v41
    v_and_b32 v41, s7, v41
    v_rcp_f32 v42, v41
    v_sub_f32 v104, v104, v40
    v_sub_f32 v105, v105, v40
    v_cvt_pk_bf16_f32 v43, v104, v105
    v_lshlrev_b32 v104, 16, v43
    v_and_b32 v105, s7, v43
    v_mul_f32 v104, v104, v42
    v_mul_f32 v105, v105, v42
    v_cvt_pk_bf16_f32 v96, v104, v105
    v_sub_f32 v106, v106, v40
    v_sub_f32 v107, v107, v40
    v_cvt_pk_bf16_f32 v43, v106, v107
    v_lshlrev_b32 v106, 16, v43
    v_and_b32 v107, s7, v43
    v_mul_f32 v106, v106, v42
    v_mul_f32 v107, v107, v42
    v_cvt_pk_bf16_f32 v97, v106, v107
    v_sub_f32 v108, v108, v40
    v_sub_f32 v109, v109, v40
    v_cvt_pk_bf16_f32 v43, v108, v109
    v_lshlrev_b32 v108, 16, v43
    v_and_b32 v109, s7, v43
    v_mul_f32 v108, v108, v42
    v_mul_f32 v109, v109, v42
    v_cvt_pk_bf16_f32 v98, v108, v109
    v_sub_f32 v110, v110, v40
    v_sub_f32 v111, v111, v40
    v_cvt_pk_bf16_f32 v43, v110, v111
    v_lshlrev_b32 v110, 16, v43
    v_and_b32 v111, s7, v43
    v_mul_f32 v110, v110, v42
    v_mul_f32 v111, v111, v42
    v_cvt_pk_bf16_f32 v99, v110, v111
    v_sub_f32 v112, v112, v40
    v_sub_f32 v113, v113, v40
    v_cvt_pk_bf16_f32 v43, v112, v113
    v_lshlrev_b32 v112, 16, v43
    v_and_b32 v113, s7, v43
    v_mul_f32 v112, v112, v42
    v_mul_f32 v113, v113, v42
    v_cvt_pk_bf16_f32 v100, v112, v113
    v_sub_f32 v114, v114, v40
    v_sub_f32 v115, v115, v40
    v_cvt_pk_bf16_f32 v43, v114, v115
    v_lshlrev_b32 v114, 16, v43
    v_and_b32 v115, s7, v43
    v_mul_f32 v114, v114, v42
    v_mul_f32 v115, v115, v42
    v_cvt_pk_bf16_f32 v101, v114, v115
    v_sub_f32 v116, v116, v40
    v_sub_f32 v117, v117, v40
    v_cvt_pk_bf16_f32 v43, v116, v117
    v_lshlrev_b32 v116, 16, v43
    v_and_b32 v117, s7, v43
    v_mul_f32 v116, v116, v42
    v_mul_f32 v117, v117, v42
    v_cvt_pk_bf16_f32 v102, v116, v117
    v_sub_f32 v118, v118, v40
    v_sub_f32 v119, v119, v40
    v_cvt_pk_bf16_f32 v43, v118, v119
    v_lshlrev_b32 v118, 16, v43
    v_and_b32 v119, s7, v43
    v_mul_f32 v118, v118, v42
    v_mul_f32 v119, v119, v42
    v_cvt_pk_bf16_f32 v103, v118, v119
    s_waitcnt vmcnt(1)
    s_add_u32 m0, s47, 2048
    s_mov_b32 s40, 262144
    buffer_load_dwordx4 v2, s[8:11], s40 offen nt lds
    s_waitcnt vmcnt(1)
    s_add_u32 m0, s47, 3072
    s_mov_b32 s40, 393216
    buffer_load_dwordx4 v2, s[8:11], s40 offen nt lds
    ds_write_b128 v11, v[96:99] offset:5760
    ds_write_b128 v11, v[100:103] offset:6272
    s_waitcnt vmcnt(0) lgkmcnt(0)
    s_mov_b64 exec, 1
    ds_write_b32 v30, v29 offset:2432
    s_mov_b64 exec, -1
    s_mov_b32 s44, 262144
L_hs1:
    ds_read_b32 v40, v31 offset:2432
    s_waitcnt lgkmcnt(0)
    v_cmp_ne_u32 vcc, 1, v40
    s_sub_u32 s44, s44, 1
    s_cbranch_vccz L_hs1_ok
    s_cmp_lg_u32 s44, 0
    s_cbranch_scc1 L_hs1
L_hs1_ok:
    s_cmp_ge_u32 s45, 2
    s_cbranch_scc1 L_pf_ffn
    s_lshl_b32 s40, s5, 17
    s_lshl_b32 s41, s4, 14
    s_add_u32 s40, s40, s41
    s_lshl_b32 s41, s45, 13
    s_add_u32 s40, s40, s41
    v_lshl_add_u32 v60, v0, 7, s40
    global_load_dword v61, v60, s[24:25]
    s_branch L_pf_done
L_pf_ffn:
    s_lshr_b32 s40, s2, 3
    s_and_b32 s41, s40, 3
    s_lshl_b32 s41, s41, 3
    s_and_b32 s42, s2, 7
    s_add_u32 s41, s41, s42
    s_cmp_ge_u32 s41, 28
    s_cbranch_scc1 L_pf_done
    s_lshr_b32 s40, s40, 2
    s_mul_i32 s42, s40, 229376
    s_lshl_b32 s43, s41, 7
    s_add_u32 s42, s42, s43
    v_mul_u32_u24 v60, 3584, v0
    v_add_u32 v60, s42, v60
    s_cmp_eq_u32 s45, 3
    s_cbranch_scc1 L_pf_up
    global_load_dword v61, v60, s[28:29]
    s_lshl_b32 s42, s41, 16
    s_lshl_b32 s43, s40, 13
    s_add_u32 s42, s42, s43
    v_lshl_add_u32 v60, v0, 7, s42
    global_load_dword v62, v60, s[32:33]
    s_branch L_pf_done
L_pf_up:
    global_load_dword v61, v60, s[30:31]
L_pf_done:
    s_cmp_lg_u32 s45, 0
    s_cbranch_scc1 L_qwait
    ds_read_b64_tr_b16 v[128:129], v26 offset:30464
    ds_read_b64_tr_b16 v[130:131], v26 offset:30720
    ds_read_b64_tr_b16 v[132:133], v26 offset:30496
    ds_read_b64_tr_b16 v[134:135], v26 offset:30752
    ds_read_b128 v[136:139], v27 offset:5760
    ds_read_b64_tr_b16 v[140:141], v26 offset:32512
    ds_read_b64_tr_b16 v[142:143], v26 offset:32768
    ds_read_b64_tr_b16 v[144:145], v26 offset:32544
    ds_read_b64_tr_b16 v[146:147], v26 offset:32800
    ds_read_b128 v[148:151], v27 offset:5824
    v_cmp_lt_u32 vcc, 1, v5
    v_mov_b32 v44, s90
    v_mov_b32 v45, s91
    v_cndmask_b32 v44, v44, v45, vcc
    v_and_b32 v45, 1, v5
    v_lshlrev_b32 v45, 4, v45
    v_lshrrev_b32 v44, v45, v44
    v_lshrrev_b32 v45, 4, v44
    v_lshrrev_b32 v46, 8, v44
    v_lshrrev_b32 v47, 12, v44
    v_cmp_lt_u32 vcc, 7, v4
    ds_read_b64_tr_b16 v[152:153], v26 offset:34560
    ds_read_b64_tr_b16 v[154:155], v26 offset:34816
    ds_read_b64_tr_b16 v[156:157], v26 offset:34592
    ds_read_b64_tr_b16 v[158:159], v26 offset:34848
    ds_read_b128 v[160:163], v27 offset:5888
    s_waitcnt lgkmcnt(10)
    v_mfma_f32_16x16x32_bf16 v[48:51], v[128:131], v[136:139], 0
    v_mfma_f32_16x16x32_bf16 v[52:55], v[132:135], v[136:139], 0
    ds_read_b64_tr_b16 v[164:165], v26 offset:36608
    ds_read_b64_tr_b16 v[166:167], v26 offset:36864
    ds_read_b64_tr_b16 v[168:169], v26 offset:36640
    ds_read_b64_tr_b16 v[170:171], v26 offset:36896
    ds_read_b128 v[172:175], v27 offset:5952
    s_waitcnt lgkmcnt(10)
    v_mfma_f32_16x16x32_bf16 v[48:51], v[140:143], v[148:151], v[48:51]
    v_mfma_f32_16x16x32_bf16 v[52:55], v[144:147], v[148:151], v[52:55]
    ds_read_b64_tr_b16 v[176:177], v26 offset:38656
    ds_read_b64_tr_b16 v[178:179], v26 offset:38912
    ds_read_b64_tr_b16 v[180:181], v26 offset:38688
    ds_read_b64_tr_b16 v[182:183], v26 offset:38944
    ds_read_b128 v[184:187], v27 offset:6016
    s_waitcnt lgkmcnt(10)
    v_mfma_f32_16x16x32_bf16 v[48:51], v[152:155], v[160:163], v[48:51]
    v_mfma_f32_16x16x32_bf16 v[52:55], v[156:159], v[160:163], v[52:55]
    ds_read_b64_tr_b16 v[188:189], v26 offset:40704
    ds_read_b64_tr_b16 v[190:191], v26 offset:40960
    ds_read_b64_tr_b16 v[192:193], v26 offset:40736
    ds_read_b64_tr_b16 v[194:195], v26 offset:40992
    ds_read_b128 v[196:199], v27 offset:6080
    s_waitcnt lgkmcnt(10)
    v_mfma_f32_16x16x32_bf16 v[48:51], v[164:167], v[172:175], v[48:51]
    v_mfma_f32_16x16x32_bf16 v[52:55], v[168:171], v[172:175], v[52:55]
    ds_read_b64_tr_b16 v[200:201], v26 offset:42752
    ds_read_b64_tr_b16 v[202:203], v26 offset:43008
    ds_read_b64_tr_b16 v[204:205], v26 offset:42784
    ds_read_b64_tr_b16 v[206:207], v26 offset:43040
    ds_read_b128 v[208:211], v27 offset:6144
    s_waitcnt lgkmcnt(10)
    v_mfma_f32_16x16x32_bf16 v[48:51], v[176:179], v[184:187], v[48:51]
    v_mfma_f32_16x16x32_bf16 v[52:55], v[180:183], v[184:187], v[52:55]
    ds_read_b64_tr_b16 v[212:213], v26 offset:44800
    ds_read_b64_tr_b16 v[214:215], v26 offset:45056
    ds_read_b64_tr_b16 v[216:217], v26 offset:44832
    ds_read_b64_tr_b16 v[218:219], v26 offset:45088
    ds_read_b128 v[220:223], v27 offset:6208
    s_waitcnt lgkmcnt(10)
    v_mfma_f32_16x16x32_bf16 v[48:51], v[188:191], v[196:199], v[48:51]
    v_mfma_f32_16x16x32_bf16 v[52:55], v[192:195], v[196:199], v[52:55]
    s_waitcnt lgkmcnt(5)
    v_mfma_f32_16x16x32_bf16 v[48:51], v[200:203], v[208:211], v[48:51]
    v_mfma_f32_16x16x32_bf16 v[52:55], v[204:207], v[208:211], v[52:55]
    s_waitcnt lgkmcnt(0)
    v_mfma_f32_16x16x32_bf16 v[48:51], v[212:215], v[220:223], v[48:51]
    v_mfma_f32_16x16x32_bf16 v[52:55], v[216:219], v[220:223], v[52:55]
    s_nop 7
    v_cndmask_b32 v48, v48, v52, vcc
    v_bfi_b32 v48, 15, v44, v48
    v_cndmask_b32 v49, v49, v53, vcc
    v_bfi_b32 v49, 15, v45, v49
    v_cndmask_b32 v50, v50, v54, vcc
    v_bfi_b32 v50, 15, v46, v50
    v_cndmask_b32 v51, v51, v55, vcc
    v_bfi_b32 v51, 15, v47, v51
    buffer_store_dwordx4 v[48:51], v28, s[96:99], 0 offen sc1
L_qwait:
    v_bfe_u32 v40, v0, 3, 1
    v_cmp_eq_u32 vcc, 1, v40
    v_mov_b32 v40, s90
    v_mov_b32 v41, s91
    v_cndmask_b32 v40, v40, v41, vcc
    v_and_b32 v41, 7, v0
    v_lshlrev_b32 v41, 2, v41
    v_bfe_u32 v40, v40, v41, 4
    s_mov_b64 s[100:101], s[52:53]
    s_and_b32 s89, s90, 15
    s_mov_b32 s92, 262144
L_qhint:
    s_load_dwordx16 s[8:23], s[96:97], s93 offset:0 glc
    s_load_dwordx16 s[24:39], s[96:97], s93 offset:64 glc
    s_load_dwordx16 s[40:55], s[96:97], s93 offset:4096 glc
    s_load_dwordx16 s[56:71], s[96:97], s93 offset:4160 glc
    s_sub_u32 s92, s92, 1
    s_cbranch_scc1 L_qgo
    s_waitcnt lgkmcnt(0)
    s_xor_b32 s4, s8, s40
    s_and_b32 s4, s4, 15
    s_cbranch_scc1 L_qhint
    s_and_b32 s4, s8, 15
    s_cmp_lg_u32 s4, s89
    s_cbranch_scc1 L_qhint
    v_writelane_b32 v64, s8, 0
    v_writelane_b32 v64, s9, 1
    v_writelane_b32 v64, s10, 2
    v_writelane_b32 v64, s11, 3
    v_writelane_b32 v64, s12, 4
    v_writelane_b32 v64, s13, 5
    v_writelane_b32 v64, s14, 6
    v_writelane_b32 v64, s15, 7
    v_writelane_b32 v64, s16, 8
    v_writelane_b32 v64, s17, 9
    v_writelane_b32 v64, s18, 10
    v_writelane_b32 v64, s19, 11
    v_writelane_b32 v64, s20, 12
    v_writelane_b32 v64, s21, 13
    v_writelane_b32 v64, s22, 14
    v_writelane_b32 v64, s23, 15
    v_writelane_b32 v64, s24, 16
    v_writelane_b32 v64, s25, 17
    v_writelane_b32 v64, s26, 18
    v_writelane_b32 v64, s27, 19
    v_writelane_b32 v64, s28, 20
    v_writelane_b32 v64, s29, 21
    v_writelane_b32 v64, s30, 22
    v_writelane_b32 v64, s31, 23
    v_writelane_b32 v64, s32, 24
    v_writelane_b32 v64, s33, 25
    v_writelane_b32 v64, s34, 26
    v_writelane_b32 v64, s35, 27
    v_writelane_b32 v64, s36, 28
    v_writelane_b32 v64, s37, 29
    v_writelane_b32 v64, s38, 30
    v_writelane_b32 v64, s39, 31
    v_writelane_b32 v64, s40, 32
    v_writelane_b32 v64, s41, 33
    v_writelane_b32 v64, s42, 34
    v_writelane_b32 v64, s43, 35
    v_writelane_b32 v64, s44, 36
    v_writelane_b32 v64, s45, 37
    v_writelane_b32 v64, s46, 38
    v_writelane_b32 v64, s47, 39
    v_writelane_b32 v64, s48, 40
    v_writelane_b32 v64, s49, 41
    v_writelane_b32 v64, s50, 42
    v_writelane_b32 v64, s51, 43
    v_writelane_b32 v64, s52, 44
    v_writelane_b32 v64, s53, 45
    v_writelane_b32 v64, s54, 46
    v_writelane_b32 v64, s55, 47
    v_writelane_b32 v64, s56, 48
    v_writelane_b32 v64, s57, 49
    v_writelane_b32 v64, s58, 50
    v_writelane_b32 v64, s59, 51
    v_writelane_b32 v64, s60, 52
    v_writelane_b32 v64, s61, 53
    v_writelane_b32 v64, s62, 54
    v_writelane_b32 v64, s63, 55
    v_writelane_b32 v64, s64, 56
    v_writelane_b32 v64, s65, 57
    v_writelane_b32 v64, s66, 58
    v_writelane_b32 v64, s67, 59
    v_writelane_b32 v64, s68, 60
    v_writelane_b32 v64, s69, 61
    v_writelane_b32 v64, s70, 62
    v_writelane_b32 v64, s71, 63
    v_and_b32 v41, 15, v64
    v_cmp_ne_u32 vcc, v41, v40
    s_cbranch_vccnz L_qhint
L_qgo:
    s_waitcnt lgkmcnt(0)
    s_load_dwordx16 s[16:31], s[0:1], 0
    s_load_dwordx8 s[32:39], s[0:1], 64
    s_mov_b64 s[52:53], s[100:101]
    s_sub_u32 s45, s3, 4
    s_lshr_b32 s4, s2, 5
    s_and_b32 s5, s2, 31
    v_and_b32 v64, -16, v64
    v_mov_b32 v65, v64
    s_nop 1
    v_permlane32_swap_b32 v64, v65
    v_add_f32 v64, v64, v65
    v_cvt_pk_bf16_f32 v64, v64, v64
    s_mov_b32 exec_lo, -1
    s_mov_b32 exec_hi, 0
    ds_write_b16 v12, v64 offset:0
    s_mov_b64 exec, -1
    s_waitcnt lgkmcnt(0)
    s_barrier
    s_setprio 0
    s_waitcnt vmcnt(0)
    s_mov_b32 s8, s24
    s_mov_b32 s9, s25
    s_mov_b32 s10, 0x400000
    s_mov_b32 s11, 0x20000
    s_lshl_b32 s43, s5, 17
    s_lshl_b32 s46, s45, 8
    s_add_u32 s43, s43, s46
    v_lshlrev_b32 v2, 10, v5
    v_lshl_add_u32 v2, v4, 4, v2
    v_add_u32 v2, s43, v2
    s_lshl_b32 s47, s45, 14
    s_add_u32 s47, s47, 30464
    v_add_u32 v13, s47, v13
    v_add_u32 v15, s47, v15
    v_bfe_u32 v6, v4, 1, 1
    v_lshl_add_u32 v16, v6, 4, v15
    s_add_u32 m0, s47, 0
    s_mov_b32 s40, 0
    buffer_load_dwordx4 v2, s[8:11], s40 offen nt lds
    s_add_u32 m0, s47, 1024
    s_mov_b32 s40, 4096
    buffer_load_dwordx4 v2, s[8:11], s40 offen nt lds
    s_waitcnt vmcnt(1)
    s_add_u32 m0, s47, 2048
    s_mov_b32 s40, 8192
    buffer_load_dwordx4 v2, s[8:11], s40 offen nt lds
    s_waitcnt vmcnt(1)
    s_add_u32 m0, s47, 3072
    s_mov_b32 s40, 12288
    buffer_load_dwordx4 v2, s[8:11], s40 offen nt lds
    s_waitcnt vmcnt(1)
    s_add_u32 m0, s47, 4096
    s_mov_b32 s40, 16384
    buffer_load_dwordx4 v2, s[8:11], s40 offen nt lds
    s_waitcnt vmcnt(1)
    s_add_u32 m0, s47, 5120
    s_mov_b32 s40, 20480
    buffer_load_dwordx4 v2, s[8:11], s40 offen nt lds
    s_waitcnt vmcnt(1)
    s_add_u32 m0, s47, 6144
    s_mov_b32 s40, 24576
    buffer_load_dwordx4 v2, s[8:11], s40 offen nt lds
    s_waitcnt vmcnt(1)
    s_add_u32 m0, s47, 7168
    s_mov_b32 s40, 28672
    buffer_load_dwordx4 v2, s[8:11], s40 offen nt lds
    s_waitcnt vmcnt(1)
    s_add_u32 m0, s47, 8192
    s_mov_b32 s40, 32768
    buffer_load_dwordx4 v2, s[8:11], s40 offen nt lds
    s_waitcnt vmcnt(1)
    s_add_u32 m0, s47, 9216
    s_mov_b32 s40, 36864
    buffer_load_dwordx4 v2, s[8:11], s40 offen nt lds
    s_waitcnt vmcnt(1)
    s_add_u32 m0, s47, 10240
    s_mov_b32 s40, 40960
    buffer_load_dwordx4 v2, s[8:11], s40 offen nt lds
    s_waitcnt vmcnt(1)
    s_add_u32 m0, s47, 11264
    s_mov_b32 s40, 45056
    buffer_load_dwordx4 v2, s[8:11], s40 offen nt lds
    s_waitcnt vmcnt(1)
    s_add_u32 m0, s47, 12288
    s_mov_b32 s40, 49152
    buffer_load_dwordx4 v2, s[8:11], s40 offen nt lds
    s_waitcnt vmcnt(1)
    s_add_u32 m0, s47, 13312
    s_mov_b32 s40, 53248
    buffer_load_dwordx4 v2, s[8:11], s40 offen nt lds
    s_waitcnt vmcnt(1)
    s_add_u32 m0, s47, 14336
    s_mov_b32 s40, 57344
    buffer_load_dwordx4 v2, s[8:11], s40 offen nt lds
    s_waitcnt vmcnt(1)
    s_add_u32 m0, s47, 15360
    s_mov_b32 s40, 61440
    buffer_load_dwordx4 v2, s[8:11], s40 offen nt lds
    s_waitcnt vmcnt(8)
    ds_read_b64_tr_b16 v[128:129], v16 offset:0
    ds_read_b64_tr_b16 v[130:131], v16 offset:1024
    ds_read_b64_tr_b16 v[132:133], v16 offset:16
    ds_read_b64_tr_b16 v[134:135], v16 offset:1040
    ds_read_b64_tr_b16 v[136:137], v16 offset:64
    ds_read_b64_tr_b16 v[138:139], v16 offset:1088
    ds_read_b64_tr_b16 v[140:141], v16 offset:80
    ds_read_b64_tr_b16 v[142:143], v16 offset:1104
    s_waitcnt lgkmcnt(0)
    ds_read_b64_tr_b16 v[144:145], v16 offset:128
    ds_read_b64_tr_b16 v[146:147], v16 offset:1152
    ds_read_b64_tr_b16 v[148:149], v16 offset:144
    ds_read_b64_tr_b16 v[150:151], v16 offset:1168
    ds_read_b64_tr_b16 v[152:153], v16 offset:192
    ds_read_b64_tr_b16 v[154:155], v16 offset:1216
    ds_read_b64_tr_b16 v[156:157], v16 offset:208
    ds_read_b64_tr_b16 v[158:159], v16 offset:1232
    s_waitcnt lgkmcnt(0)
    s_waitcnt vmcnt(1)
    s_add_u32 m0, s47, 0
    s_mov_b32 s40, 65536
    buffer_load_dwordx4 v2, s[8:11], s40 offen nt lds
    s_waitcnt vmcnt(1)
    s_add_u32 m0, s47, 1024
    s_mov_b32 s40, 69632
    buffer_load_dwordx4 v2, s[8:11], s40 offen nt lds
    s_waitcnt vmcnt(1)
    s_add_u32 m0, s47, 2048
    s_mov_b32 s40, 73728
    buffer_load_dwordx4 v2, s[8:11], s40 offen nt lds
    s_waitcnt vmcnt(1)
    s_add_u32 m0, s47, 3072
    s_mov_b32 s40, 77824
    buffer_load_dwordx4 v2, s[8:11], s40 offen nt lds
    s_waitcnt vmcnt(1)
    s_add_u32 m0, s47, 4096
    s_mov_b32 s40, 81920
    buffer_load_dwordx4 v2, s[8:11], s40 offen nt lds
    s_waitcnt vmcnt(1)
    s_add_u32 m0, s47, 5120
    s_mov_b32 s40, 86016
    buffer_load_dwordx4 v2, s[8:11], s40 offen nt lds
    s_waitcnt vmcnt(1)
    s_add_u32 m0, s47, 6144
    s_mov_b32 s40, 90112
    buffer_load_dwordx4 v2, s[8:11], s40 offen nt lds
    s_waitcnt vmcnt(1)
    s_add_u32 m0, s47, 7168
    s_mov_b32 s40, 94208
    buffer_load_dwordx4 v2, s[8:11], s40 offen nt lds
    s_waitcnt vmcnt(8)
    ds_read_b64_tr_b16 v[160:161], v16 offset:8192
    ds_read_b64_tr_b16 v[162:163], v16 offset:9216
    ds_read_b64_tr_b16 v[164:165], v16 offset:8208
    ds_read_b64_tr_b16 v[166:167], v16 offset:9232
    ds_read_b64_tr_b16 v[168:169], v16 offset:8256
    ds_read_b64_tr_b16 v[170:171], v16 offset:9280
    ds_read_b64_tr_b16 v[172:173], v16 offset:8272
    ds_read_b64_tr_b16 v[174:175], v16 offset:9296
    s_waitcnt lgkmcnt(0)
    ds_read_b64_tr_b16 v[176:177], v16 offset:8320
    ds_read_b64_tr_b16 v[178:179], v16 offset:9344
    ds_read_b64_tr_b16 v[180:181], v16 offset:8336
    ds_read_b64_tr_b16 v[182:183], v16 offset:9360
    ds_read_b64_tr_b16 v[184:185], v16 offset:8384
    ds_read_b64_tr_b16 v[186:187], v16 offset:9408
    ds_read_b64_tr_b16 v[188:189], v16 offset:8400
    ds_read_b64_tr_b16 v[190:191], v16 offset:9424
    s_waitcnt lgkmcnt(0)
    s_waitcnt vmcnt(1)
    s_add_u32 m0, s47, 8192
    s_mov_b32 s40, 98304
    buffer_load_dwordx4 v2, s[8:11], s40 offen nt lds
    s_waitcnt vmcnt(1)
    s_add_u32 m0, s47, 9216
    s_mov_b32 s40, 102400
    buffer_load_dwordx4 v2, s[8:11], s40 offen nt lds
    s_waitcnt vmcnt(1)
    s_add_u32 m0, s47, 10240
    s_mov_b32 s40, 106496
    buffer_load_dwordx4 v2, s[8:11], s40 offen nt lds
    s_waitcnt vmcnt(1)
    s_add_u32 m0, s47, 11264
    s_mov_b32 s40, 110592
    buffer_load_dwordx4 v2, s[8:11], s40 offen nt lds
    s_waitcnt vmcnt(1)
    s_add_u32 m0, s47, 12288
    s_mov_b32 s40, 114688
    buffer_load_dwordx4 v2, s[8:11], s40 offen nt lds
    s_waitcnt vmcnt(1)
    s_add_u32 m0, s47, 13312
    s_mov_b32 s40, 118784
    buffer_load_dwordx4 v2, s[8:11], s40 offen nt lds
    s_waitcnt vmcnt(1)
    s_add_u32 m0, s47, 14336
    s_mov_b32 s40, 122880
    buffer_load_dwordx4 v2, s[8:11], s40 offen nt lds
    s_waitcnt vmcnt(1)
    s_add_u32 m0, s47, 15360
    s_mov_b32 s40, 126976
    buffer_load_dwordx4 v2, s[8:11], s40 offen nt lds
    s_waitcnt vmcnt(8)
    ds_read_b64_tr_b16 v[192:193], v16 offset:0
    ds_read_b64_tr_b16 v[194:195], v16 offset:1024
    ds_read_b64_tr_b16 v[196:197], v16 offset:16
    ds_read_b64_tr_b16 v[198:199], v16 offset:1040
    ds_read_b64_tr_b16 v[200:201], v16 offset:64
    ds_read_b64_tr_b16 v[202:203], v16 offset:1088
    ds_read_b64_tr_b16 v[204:205], v16 offset:80
    ds_read_b64_tr_b16 v[206:207], v16 offset:1104
    s_waitcnt lgkmcnt(0)
    ds_read_b64_tr_b16 v[208:209], v16 offset:128
    ds_read_b64_tr_b16 v[210:211], v16 offset:1152
    ds_read_b64_tr_b16 v[212:213], v16 offset:144
    ds_read_b64_tr_b16 v[214:215], v16 offset:1168
    ds_read_b64_tr_b16 v[216:217], v16 offset:192
    ds_read_b64_tr_b16 v[218:219], v16 offset:1216
    ds_read_b64_tr_b16 v[220:221], v16 offset:208
    ds_read_b64_tr_b16 v[222:223], v16 offset:1232
    s_waitcnt lgkmcnt(0)
    s_waitcnt vmcnt(0)
    ds_read_b64_tr_b16 v[224:225], v16 offset:8192
    ds_read_b64_tr_b16 v[226:227], v16 offset:9216
    ds_read_b64_tr_b16 v[228:229], v16 offset:8208
    ds_read_b64_tr_b16 v[230:231], v16 offset:9232
    ds_read_b64_tr_b16 v[232:233], v16 offset:8256
    ds_read_b64_tr_b16 v[234:235], v16 offset:9280
    ds_read_b64_tr_b16 v[236:237], v16 offset:8272
    ds_read_b64_tr_b16 v[238:239], v16 offset:9296
    s_waitcnt lgkmcnt(0)
    ds_read_b64_tr_b16 v[240:241], v16 offset:8320
    ds_read_b64_tr_b16 v[242:243], v16 offset:9344
    ds_read_b64_tr_b16 v[244:245], v16 offset:8336
    ds_read_b64_tr_b16 v[246:247], v16 offset:9360
    ds_read_b64_tr_b16 v[248:249], v16 offset:8384
    ds_read_b64_tr_b16 v[250:251], v16 offset:9408
    ds_read_b64_tr_b16 v[252:253], v16 offset:8400
    ds_read_b64_tr_b16 v[254:255], v16 offset:9424
    s_waitcnt lgkmcnt(0)
    s_cmp_ge_u32 s95, 28
    s_cbranch_scc1 L_noffn
    v_lshrrev_b32 v6, 3, v0
    v_and_b32 v7, 7, v0
    s_mul_i32 s43, s45, 28672
    s_lshl_b32 s46, s95, 7
    s_add_u32 s43, s43, s46
    v_mul_u32_u24 v10, 3584, v6
    v_lshl_add_u32 v10, v7, 4, v10
    v_add_u32 v10, s43, v10
    s_lshl_b32 s43, s95, 16
    s_lshl_b32 s46, s45, 8
    s_add_u32 s43, s43, s46
    v_lshlrev_b32 v11, 10, v5
    v_lshl_add_u32 v11, v4, 4, v11
    v_add_u32 v11, s43, v11
    s_mov_b32 s8, s28
    s_mov_b32 s9, s29
    s_mov_b32 s10, 1835008
    s_mov_b32 s48, s30
    s_mov_b32 s49, s31
    s_mov_b32 s50, 1835008
    s_mov_b32 s51, 0x20000
    s_mov_b32 s12, s32
    s_mov_b32 s13, s33
    s_mov_b32 s14, 1835008
    s_mov_b32 s15, 0x20000
    s_lshl_b32 s43, s45, 4
    v_add_u32 v14, s43, v14
    v_mul_u32_u24 v6, 48, v5
    v_add_u32 v14, v6, v14
    s_waitcnt vmcnt(2)
    s_add_u32 m0, s47, 0
    s_mov_b32 s40, 0
    buffer_load_dwordx4 v10, s[8:11], s40 offen nt lds
    s_waitcnt vmcnt(2)
    s_add_u32 m0, s47, 1024
    s_mov_b32 s40, 114688
    buffer_load_dwordx4 v10, s[8:11], s40 offen nt lds
    s_waitcnt vmcnt(2)
    s_add_u32 m0, s47, 2048
    s_mov_b32 s40, 229376
    buffer_load_dwordx4 v10, s[8:11], s40 offen nt lds
    s_waitcnt vmcnt(2)
    s_add_u32 m0, s47, 3072
    s_mov_b32 s40, 344064
    buffer_load_dwordx4 v10, s[8:11], s40 offen nt lds
    s_waitcnt vmcnt(2)
    s_add_u32 m0, s47, 4096
    s_mov_b32 s40, 0
    buffer_load_dwordx4 v10, s[48:51], s40 offen nt lds
    s_waitcnt vmcnt(2)
    s_add_u32 m0, s47, 5120
    s_mov_b32 s40, 114688
    buffer_load_dwordx4 v10, s[48:51], s40 offen nt lds
    s_waitcnt vmcnt(2)
    s_add_u32 m0, s47, 6144
    s_mov_b32 s40, 229376
    buffer_load_dwordx4 v10, s[48:51], s40 offen nt lds
    s_waitcnt vmcnt(2)
    s_add_u32 m0, s47, 7168
    s_mov_b32 s40, 344064
    buffer_load_dwordx4 v10, s[48:51], s40 offen nt lds
    s_waitcnt vmcnt(2)
    s_add_u32 m0, s47, 8192
    s_mov_b32 s40, 458752
    buffer_load_dwordx4 v10, s[8:11], s40 offen nt lds
    s_waitcnt vmcnt(2)
    s_add_u32 m0, s47, 9216
    s_mov_b32 s40, 573440
    buffer_load_dwordx4 v10, s[8:11], s40 offen nt lds
    s_waitcnt vmcnt(2)
    s_add_u32 m0, s47, 10240
    s_mov_b32 s40, 688128
    buffer_load_dwordx4 v10, s[8:11], s40 offen nt lds
    s_waitcnt vmcnt(2)
    s_add_u32 m0, s47, 11264
    s_mov_b32 s40, 802816
    buffer_load_dwordx4 v10, s[8:11], s40 offen nt lds
    s_waitcnt vmcnt(2)
    s_add_u32 m0, s47, 12288
    s_mov_b32 s40, 458752
    buffer_load_dwordx4 v10, s[48:51], s40 offen nt lds
    s_waitcnt vmcnt(2)
    s_add_u32 m0, s47, 13312
    s_mov_b32 s40, 573440
    buffer_load_dwordx4 v10, s[48:51], s40 offen nt lds
    s_waitcnt vmcnt(2)
    s_add_u32 m0, s47, 14336
    s_mov_b32 s40, 688128
    buffer_load_dwordx4 v10, s[48:51], s40 offen nt lds
    s_waitcnt vmcnt(2)
    s_add_u32 m0, s47, 15360
    s_mov_b32 s40, 802816
    buffer_load_dwordx4 v10, s[48:51], s40 offen nt lds
    s_waitcnt vmcnt(8)
    ds_read_b128 v[16:19], v14 offset:5760
    ds_read_b64_tr_b16 v[96:97], v13 offset:0
    ds_read_b64_tr_b16 v[98:99], v13 offset:512
    ds_read_b64_tr_b16 v[100:101], v13 offset:32
    ds_read_b64_tr_b16 v[102:103], v13 offset:544
    ds_read_b64_tr_b16 v[104:105], v13 offset:64
    ds_read_b64_tr_b16 v[106:107], v13 offset:576
    ds_read_b64_tr_b16 v[108:109], v13 offset:96
    ds_read_b64_tr_b16 v[110:111], v13 offset:608
    s_waitcnt lgkmcnt(0)
    v_mfma_f32_16x16x32_bf16 v[64:67], v[96:99], v[16:19], 0
    v_mfma_f32_16x16x32_bf16 v[68:71], v[100:103], v[16:19], 0
    v_mfma_f32_16x16x32_bf16 v[72:75], v[104:107], v[16:19], 0
    v_mfma_f32_16x16x32_bf16 v[76:79], v[108:111], v[16:19], 0
    ds_read_b64_tr_b16 v[112:113], v13 offset:4096
    ds_read_b64_tr_b16 v[114:115], v13 offset:4608
    ds_read_b64_tr_b16 v[116:117], v13 offset:4128
    ds_read_b64_tr_b16 v[118:119], v13 offset:4640
    ds_read_b64_tr_b16 v[120:121], v13 offset:4160
    ds_read_b64_tr_b16 v[122:123], v13 offset:4672
    ds_read_b64_tr_b16 v[124:125], v13 offset:4192
    ds_read_b64_tr_b16 v[126:127], v13 offset:4704
    s_waitcnt lgkmcnt(0)
    v_mfma_f32_16x16x32_bf16 v[80:83], v[112:115], v[16:19], 0
    v_mfma_f32_16x16x32_bf16 v[84:87], v[116:119], v[16:19], 0
    v_mfma_f32_16x16x32_bf16 v[88:91], v[120:123], v[16:19], 0
    v_mfma_f32_16x16x32_bf16 v[92:95], v[124:127], v[16:19], 0
    s_waitcnt vmcnt(2)
    s_add_u32 m0, s47, 0
    s_mov_b32 s40, 917504
    buffer_load_dwordx4 v10, s[8:11], s40 offen nt lds
    s_waitcnt vmcnt(2)
    s_add_u32 m0, s47, 1024
    s_mov_b32 s40, 1032192
    buffer_load_dwordx4 v10, s[8:11], s40 offen nt lds
    s_waitcnt vmcnt(2)
    s_add_u32 m0, s47, 2048
    s_mov_b32 s40, 1146880
    buffer_load_dwordx4 v10, s[8:11], s40 offen nt lds
    s_waitcnt vmcnt(2)
    s_add_u32 m0, s47, 3072
    s_mov_b32 s40, 1261568
    buffer_load_dwordx4 v10, s[8:11], s40 offen nt lds
    s_waitcnt vmcnt(2)
    s_add_u32 m0, s47, 4096
    s_mov_b32 s40, 917504
    buffer_load_dwordx4 v10, s[48:51], s40 offen nt lds
    s_waitcnt vmcnt(2)
    s_add_u32 m0, s47, 5120
    s_mov_b32 s40, 1032192
    buffer_load_dwordx4 v10, s[48:51], s40 offen nt lds
    s_waitcnt vmcnt(2)
    s_add_u32 m0, s47, 6144
    s_mov_b32 s40, 1146880
    buffer_load_dwordx4 v10, s[48:51], s40 offen nt lds
    s_waitcnt vmcnt(2)
    s_add_u32 m0, s47, 7168
    s_mov_b32 s40, 1261568
    buffer_load_dwordx4 v10, s[48:51], s40 offen nt lds
    s_waitcnt vmcnt(8)
    ds_read_b128 v[16:19], v14 offset:6016
    ds_read_b64_tr_b16 v[96:97], v13 offset:8192
    ds_read_b64_tr_b16 v[98:99], v13 offset:8704
    ds_read_b64_tr_b16 v[100:101], v13 offset:8224
    ds_read_b64_tr_b16 v[102:103], v13 offset:8736
    ds_read_b64_tr_b16 v[104:105], v13 offset:8256
    ds_read_b64_tr_b16 v[106:107], v13 offset:8768
    ds_read_b64_tr_b16 v[108:109], v13 offset:8288
    ds_read_b64_tr_b16 v[110:111], v13 offset:8800
    s_waitcnt lgkmcnt(0)
    v_mfma_f32_16x16x32_bf16 v[64:67], v[96:99], v[16:19], v[64:67]
    v_mfma_f32_16x16x32_bf16 v[68:71], v[100:103], v[16:19], v[68:71]
    v_mfma_f32_16x16x32_bf16 v[72:75], v[104:107], v[16:19], v[72:75]
    v_mfma_f32_16x16x32_bf16 v[76:79], v[108:111], v[16:19], v[76:79]
    ds_read_b64_tr_b16 v[112:113], v13 offset:12288
    ds_read_b64_tr_b16 v[114:115], v13 offset:12800
    ds_read_b64_tr_b16 v[116:117], v13 offset:12320
    ds_read_b64_tr_b16 v[118:119], v13 offset:12832
    ds_read_b64_tr_b16 v[120:121], v13 offset:12352
    ds_read_b64_tr_b16 v[122:123], v13 offset:12864
    ds_read_b64_tr_b16 v[124:125], v13 offset:12384
    ds_read_b64_tr_b16 v[126:127], v13 offset:12896
    s_waitcnt lgkmcnt(0)
    v_mfma_f32_16x16x32_bf16 v[80:83], v[112:115], v[16:19], v[80:83]
    v_mfma_f32_16x16x32_bf16 v[84:87], v[116:119], v[16:19], v[84:87]
    v_mfma_f32_16x16x32_bf16 v[88:91], v[120:123], v[16:19], v[88:91]
    v_mfma_f32_16x16x32_bf16 v[92:95], v[124:127], v[16:19], v[92:95]
    s_waitcnt vmcnt(2)
    s_add_u32 m0, s47, 8192
    s_mov_b32 s40, 1376256
    buffer_load_dwordx4 v10, s[8:11], s40 offen nt lds
    s_waitcnt vmcnt(2)
    s_add_u32 m0, s47, 9216
    s_mov_b32 s40, 1490944
    buffer_load_dwordx4 v10, s[8:11], s40 offen nt lds
    s_waitcnt vmcnt(2)
    s_add_u32 m0, s47, 10240
    s_mov_b32 s40, 1605632
    buffer_load_dwordx4 v10, s[8:11], s40 offen nt lds
    s_waitcnt vmcnt(2)
    s_add_u32 m0, s47, 11264
    s_mov_b32 s40, 1720320
    buffer_load_dwordx4 v10, s[8:11], s40 offen nt lds
    s_waitcnt vmcnt(2)
    s_add_u32 m0, s47, 12288
    s_mov_b32 s40, 1376256
    buffer_load_dwordx4 v10, s[48:51], s40 offen nt lds
    s_waitcnt vmcnt(2)
    s_add_u32 m0, s47, 13312
    s_mov_b32 s40, 1490944
    buffer_load_dwordx4 v10, s[48:51], s40 offen nt lds
    s_waitcnt vmcnt(2)
    s_add_u32 m0, s47, 14336
    s_mov_b32 s40, 1605632
    buffer_load_dwordx4 v10, s[48:51], s40 offen nt lds
    s_waitcnt vmcnt(2)
    s_add_u32 m0, s47, 15360
    s_mov_b32 s40, 1720320
    buffer_load_dwordx4 v10, s[48:51], s40 offen nt lds
    s_waitcnt vmcnt(8)
    ds_read_b128 v[16:19], v14 offset:6272
    ds_read_b64_tr_b16 v[96:97], v13 offset:0
    ds_read_b64_tr_b16 v[98:99], v13 offset:512
    ds_read_b64_tr_b16 v[100:101], v13 offset:32
    ds_read_b64_tr_b16 v[102:103], v13 offset:544
    ds_read_b64_tr_b16 v[104:105], v13 offset:64
    ds_read_b64_tr_b16 v[106:107], v13 offset:576
    ds_read_b64_tr_b16 v[108:109], v13 offset:96
    ds_read_b64_tr_b16 v[110:111], v13 offset:608
    s_waitcnt lgkmcnt(0)
    v_mfma_f32_16x16x32_bf16 v[64:67], v[96:99], v[16:19], v[64:67]
    v_mfma_f32_16x16x32_bf16 v[68:71], v[100:103], v[16:19], v[68:71]
    v_mfma_f32_16x16x32_bf16 v[72:75], v[104:107], v[16:19], v[72:75]
    v_mfma_f32_16x16x32_bf16 v[76:79], v[108:111], v[16:19], v[76:79]
    ds_read_b64_tr_b16 v[112:113], v13 offset:4096
    ds_read_b64_tr_b16 v[114:115], v13 offset:4608
    ds_read_b64_tr_b16 v[116:117], v13 offset:4128
    ds_read_b64_tr_b16 v[118:119], v13 offset:4640
    ds_read_b64_tr_b16 v[120:121], v13 offset:4160
    ds_read_b64_tr_b16 v[122:123], v13 offset:4672
    ds_read_b64_tr_b16 v[124:125], v13 offset:4192
    ds_read_b64_tr_b16 v[126:127], v13 offset:4704
    s_waitcnt lgkmcnt(0)
    v_mfma_f32_16x16x32_bf16 v[80:83], v[112:115], v[16:19], v[80:83]
    v_mfma_f32_16x16x32_bf16 v[84:87], v[116:119], v[16:19], v[84:87]
    v_mfma_f32_16x16x32_bf16 v[88:91], v[120:123], v[16:19], v[88:91]
    v_mfma_f32_16x16x32_bf16 v[92:95], v[124:127], v[16:19], v[92:95]
    s_waitcnt vmcnt(2)
    s_add_u32 m0, s47, 0
    s_mov_b32 s40, 0
    buffer_load_dwordx4 v11, s[12:15], s40 offen nt lds
    s_waitcnt vmcnt(2)
    s_add_u32 m0, s47, 1024
    s_mov_b32 s40, 4096
    buffer_load_dwordx4 v11, s[12:15], s40 offen nt lds
    s_waitcnt vmcnt(2)
    s_add_u32 m0, s47, 2048
    s_mov_b32 s40, 8192
    buffer_load_dwordx4 v11, s[12:15], s40 offen nt lds
    s_waitcnt vmcnt(2)
    s_add_u32 m0, s47, 3072
    s_mov_b32 s40, 12288
    buffer_load_dwordx4 v11, s[12:15], s40 offen nt lds
    s_waitcnt vmcnt(2)
    s_add_u32 m0, s47, 4096
    s_mov_b32 s40, 16384
    buffer_load_dwordx4 v11, s[12:15], s40 offen nt lds
    s_waitcnt vmcnt(2)
    s_add_u32 m0, s47, 5120
    s_mov_b32 s40, 20480
    buffer_load_dwordx4 v11, s[12:15], s40 offen nt lds
    s_waitcnt vmcnt(2)
    s_add_u32 m0, s47, 6144
    s_mov_b32 s40, 24576
    buffer_load_dwordx4 v11, s[12:15], s40 offen nt lds
    s_waitcnt vmcnt(2)
    s_add_u32 m0, s47, 7168
    s_mov_b32 s40, 28672
    buffer_load_dwordx4 v11, s[12:15], s40 offen nt lds
    s_waitcnt vmcnt(8)
    ds_read_b128 v[16:19], v14 offset:6528
    ds_read_b64_tr_b16 v[96:97], v13 offset:8192
    ds_read_b64_tr_b16 v[98:99], v13 offset:8704
    ds_read_b64_tr_b16 v[100:101], v13 offset:8224
    ds_read_b64_tr_b16 v[102:103], v13 offset:8736
    ds_read_b64_tr_b16 v[104:105], v13 offset:8256
    ds_read_b64_tr_b16 v[106:107], v13 offset:8768
    ds_read_b64_tr_b16 v[108:109], v13 offset:8288
    ds_read_b64_tr_b16 v[110:111], v13 offset:8800
    s_waitcnt lgkmcnt(0)
    v_mfma_f32_16x16x32_bf16 v[64:67], v[96:99], v[16:19], v[64:67]
    v_mfma_f32_16x16x32_bf16 v[68:71], v[100:103], v[16:19], v[68:71]
    v_mfma_f32_16x16x32_bf16 v[72:75], v[104:107], v[16:19], v[72:75]
    v_mfma_f32_16x16x32_bf16 v[76:79], v[108:111], v[16:19], v[76:79]
    ds_read_b64_tr_b16 v[112:113], v13 offset:12288
    ds_read_b64_tr_b16 v[114:115], v13 offset:12800
    ds_read_b64_tr_b16 v[116:117], v13 offset:12320
    ds_read_b64_tr_b16 v[118:119], v13 offset:12832
    ds_read_b64_tr_b16 v[120:121], v13 offset:12352
    ds_read_b64_tr_b16 v[122:123], v13 offset:12864
    ds_read_b64_tr_b16 v[124:125], v13 offset:12384
    ds_read_b64_tr_b16 v[126:127], v13 offset:12896
    s_waitcnt lgkmcnt(0)
    v_mfma_f32_16x16x32_bf16 v[80:83], v[112:115], v[16:19], v[80:83]
    v_mfma_f32_16x16x32_bf16 v[84:87], v[116:119], v[16:19], v[84:87]
    v_mfma_f32_16x16x32_bf16 v[88:91], v[120:123], v[16:19], v[88:91]
    v_mfma_f32_16x16x32_bf16 v[92:95], v[124:127], v[16:19], v[92:95]
    v_and_b32 v6, 7, v4
    v_lshl_add_u32 v6, v5, 3, v6
    v_lshlrev_b32 v6, 4, v6
    s_lshl_b32 s43, s45, 12
    v_add_u32 v7, s43, v6
    s_mov_b32 exec_lo, 0x00ff00ff
    s_mov_b32 exec_hi, 0x00ff00ff
    ds_write_b128 v7, v[64:67] offset:14080
    ds_write_b128 v7, v[68:71] offset:14592
    ds_write_b128 v7, v[72:75] offset:15104
    ds_write_b128 v7, v[76:79] offset:15616
    ds_write_b128 v7, v[80:83] offset:16128
    ds_write_b128 v7, v[84:87] offset:16640
    ds_write_b128 v7, v[88:91] offset:17152
    ds_write_b128 v7, v[92:95] offset:17664
    s_mov_b64 exec, -1
    s_waitcnt lgkmcnt(0)
    s_mov_b64 exec, 1
    ds_write_b32 v30, v29 offset:2464
    s_mov_b64 exec, -1
    s_waitcnt vmcnt(2)
    s_add_u32 m0, s47, 8192
    s_mov_b32 s40, 32768
    buffer_load_dwordx4 v11, s[12:15], s40 offen nt lds
    s_waitcnt vmcnt(2)
    s_add_u32 m0, s47, 9216
    s_mov_b32 s40, 36864
    buffer_load_dwordx4 v11, s[12:15], s40 offen nt lds
    s_waitcnt vmcnt(2)
    s_add_u32 m0, s47, 10240
    s_mov_b32 s40, 40960
    buffer_load_dwordx4 v11, s[12:15], s40 offen nt lds
    s_waitcnt vmcnt(2)
    s_add_u32 m0, s47, 11264
    s_mov_b32 s40, 45056
    buffer_load_dwordx4 v11, s[12:15], s40 offen nt lds
    s_waitcnt vmcnt(2)
    s_add_u32 m0, s47, 12288
    s_mov_b32 s40, 49152
    buffer_load_dwordx4 v11, s[12:15], s40 offen nt lds
    s_waitcnt vmcnt(2)
    s_add_u32 m0, s47, 13312
    s_mov_b32 s40, 53248
    buffer_load_dwordx4 v11, s[12:15], s40 offen nt lds
    s_waitcnt vmcnt(2)
    s_add_u32 m0, s47, 14336
    s_mov_b32 s40, 57344
    buffer_load_dwordx4 v11, s[12:15], s40 offen nt lds
    s_waitcnt vmcnt(2)
    s_add_u32 m0, s47, 15360
    s_mov_b32 s40, 61440
    buffer_load_dwordx4 v11, s[12:15], s40 offen nt lds
    s_mov_b32 s44, 262144
L_hs2:
    ds_read_b32 v40, v31 offset:2464
    s_waitcnt lgkmcnt(0)
    v_cmp_ne_u32 vcc, 1, v40
    s_sub_u32 s44, s44, 1
    s_cbranch_vccz L_hs2_ok
    s_sleep 2
    s_cmp_lg_u32 s44, 0
    s_cbranch_scc1 L_hs2
L_hs2_ok:
    ds_read_b128 v[96:99], v6 offset:14080
    ds_read_b128 v[100:103], v6 offset:18176
    ds_read_b128 v[104:107], v6 offset:22272
    ds_read_b128 v[108:111], v6 offset:26368
    s_waitcnt lgkmcnt(0)
    v_add_f32 v96, v96, v100
    v_add_f32 v104, v104, v108
    v_add_f32 v64, v96, v104
    v_add_f32 v97, v97, v101
    v_add_f32 v105, v105, v109
    v_add_f32 v65, v97, v105
    v_add_f32 v98, v98, v102
    v_add_f32 v106, v106, v110
    v_add_f32 v66, v98, v106
    v_add_f32 v99, v99, v103
    v_add_f32 v107, v107, v111
    v_add_f32 v67, v99, v107
    ds_read_b128 v[96:99], v6 offset:14592
    ds_read_b128 v[100:103], v6 offset:18688
    ds_read_b128 v[104:107], v6 offset:22784
    ds_read_b128 v[108:111], v6 offset:26880
    s_waitcnt lgkmcnt(0)
    v_add_f32 v96, v96, v100
    v_add_f32 v104, v104, v108
    v_add_f32 v68, v96, v104
    v_add_f32 v97, v97, v101
    v_add_f32 v105, v105, v109
    v_add_f32 v69, v97, v105
    v_add_f32 v98, v98, v102
    v_add_f32 v106, v106, v110
    v_add_f32 v70, v98, v106
    v_add_f32 v99, v99, v103
    v_add_f32 v107, v107, v111
    v_add_f32 v71, v99, v107
    ds_read_b128 v[96:99], v6 offset:15104
    ds_read_b128 v[100:103], v6 offset:19200
    ds_read_b128 v[104:107], v6 offset:23296
    ds_read_b128 v[108:111], v6 offset:27392
    s_waitcnt lgkmcnt(0)
    v_add_f32 v96, v96, v100
    v_add_f32 v104, v104, v108
    v_add_f32 v72, v96, v104
    v_add_f32 v97, v97, v101
    v_add_f32 v105, v105, v109
    v_add_f32 v73, v97, v105
    v_add_f32 v98, v98, v102
    v_add_f32 v106, v106, v110
    v_add_f32 v74, v98, v106
    v_add_f32 v99, v99, v103
    v_add_f32 v107, v107, v111
    v_add_f32 v75, v99, v107
    ds_read_b128 v[96:99], v6 offset:15616
    ds_read_b128 v[100:103], v6 offset:19712
    ds_read_b128 v[104:107], v6 offset:23808
    ds_read_b128 v[108:111], v6 offset:27904
    s_waitcnt lgkmcnt(0)
    v_add_f32 v96, v96, v100
    v_add_f32 v104, v104, v108
    v_add_f32 v76, v96, v104
    v_add_f32 v97, v97, v101
    v_add_f32 v105, v105, v109
    v_add_f32 v77, v97, v105
    v_add_f32 v98, v98, v102
    v_add_f32 v106, v106, v110
    v_add_f32 v78, v98, v106
    v_add_f32 v99, v99, v103
    v_add_f32 v107, v107, v111
    v_add_f32 v79, v99, v107
    ds_read_b128 v[96:99], v6 offset:16128
    ds_read_b128 v[100:103], v6 offset:20224
    ds_read_b128 v[104:107], v6 offset:24320
    ds_read_b128 v[108:111], v6 offset:28416
    s_waitcnt lgkmcnt(0)
    v_add_f32 v96, v96, v100
    v_add_f32 v104, v104, v108
    v_add_f32 v80, v96, v104
    v_add_f32 v97, v97, v101
    v_add_f32 v105, v105, v109
    v_add_f32 v81, v97, v105
    v_add_f32 v98, v98, v102
    v_add_f32 v106, v106, v110
    v_add_f32 v82, v98, v106
    v_add_f32 v99, v99, v103
    v_add_f32 v107, v107, v111
    v_add_f32 v83, v99, v107
    ds_read_b128 v[96:99], v6 offset:16640
    ds_read_b128 v[100:103], v6 offset:20736
    ds_read_b128 v[104:107], v6 offset:24832
    ds_read_b128 v[108:111], v6 offset:28928
    s_waitcnt lgkmcnt(0)
    v_add_f32 v96, v96, v100
    v_add_f32 v104, v104, v108
    v_add_f32 v84, v96, v104
    v_add_f32 v97, v97, v101
    v_add_f32 v105, v105, v109
    v_add_f32 v85, v97, v105
    v_add_f32 v98, v98, v102
    v_add_f32 v106, v106, v110
    v_add_f32 v86, v98, v106
    v_add_f32 v99, v99, v103
    v_add_f32 v107, v107, v111
    v_add_f32 v87, v99, v107
    ds_read_b128 v[96:99], v6 offset:17152
    ds_read_b128 v[100:103], v6 offset:21248
    ds_read_b128 v[104:107], v6 offset:25344
    ds_read_b128 v[108:111], v6 offset:29440
    s_waitcnt lgkmcnt(0)
    v_add_f32 v96, v96, v100
    v_add_f32 v104, v104, v108
    v_add_f32 v88, v96, v104
    v_add_f32 v97, v97, v101
    v_add_f32 v105, v105, v109
    v_add_f32 v89, v97, v105
    v_add_f32 v98, v98, v102
    v_add_f32 v106, v106, v110
    v_add_f32 v90, v98, v106
    v_add_f32 v99, v99, v103
    v_add_f32 v107, v107, v111
    v_add_f32 v91, v99, v107
    ds_read_b128 v[96:99], v6 offset:17664
    ds_read_b128 v[100:103], v6 offset:21760
    ds_read_b128 v[104:107], v6 offset:25856
    ds_read_b128 v[108:111], v6 offset:29952
    s_waitcnt lgkmcnt(0)
    v_add_f32 v96, v96, v100
    v_add_f32 v104, v104, v108
    v_add_f32 v92, v96, v104
    v_add_f32 v97, v97, v101
    v_add_f32 v105, v105, v109
    v_add_f32 v93, v97, v105
    v_add_f32 v98, v98, v102
    v_add_f32 v106, v106, v110
    v_add_f32 v94, v98, v106
    v_add_f32 v99, v99, v103
    v_add_f32 v107, v107, v111
    v_add_f32 v95, v99, v107
    s_mov_b32 s43, 0xc0135761
    s_mov_b32 s46, 0xbdd2d3e8
    v_mov_b32 v45, s43
    v_and_b32 v8, 7, v4
    v_mul_u32_u24 v8, 144, v8
    v_lshl_add_u32 v9, v5, 3, v8
    v_lshl_add_u32 v8, v5, 4, v8
    v_cvt_pk_bf16_f32 v64, v64, v64
    v_and_b32 v64, s7, v64
    v_cvt_pk_bf16_f32 v80, v80, v80
    v_and_b32 v80, s7, v80
    v_mul_f32 v42, v64, v64
    v_fma_f32 v42, v42, s46, v45
    v_mul_f32 v42, v42, v64
    v_exp_f32 v42, v42
    s_nop 0
    v_add_f32 v42, 1.0, v42
    v_rcp_f32 v42, v42
    s_nop 0
    v_mul_f32 v42, v42, v64
    v_cvt_pk_bf16_f32 v42, v42, v42
    v_and_b32 v42, s7, v42
    v_mul_f32 v64, v42, v80
    v_cvt_pk_bf16_f32 v65, v65, v65
    v_and_b32 v65, s7, v65
    v_cvt_pk_bf16_f32 v81, v81, v81
    v_and_b32 v81, s7, v81
    v_mul_f32 v42, v65, v65
    v_fma_f32 v42, v42, s46, v45
    v_mul_f32 v42, v42, v65
    v_exp_f32 v42, v42
    s_nop 0
    v_add_f32 v42, 1.0, v42
    v_rcp_f32 v42, v42
    s_nop 0
    v_mul_f32 v42, v42, v65
    v_cvt_pk_bf16_f32 v42, v42, v42
    v_and_b32 v42, s7, v42
    v_mul_f32 v65, v42, v81
    v_cvt_pk_bf16_f32 v66, v66, v66
    v_and_b32 v66, s7, v66
    v_cvt_pk_bf16_f32 v82, v82, v82
    v_and_b32 v82, s7, v82
    v_mul_f32 v42, v66, v66
    v_fma_f32 v42, v42, s46, v45
    v_mul_f32 v42, v42, v66
    v_exp_f32 v42, v42
    s_nop 0
    v_add_f32 v42, 1.0, v42
    v_rcp_f32 v42, v42
    s_nop 0
    v_mul_f32 v42, v42, v66
    v_cvt_pk_bf16_f32 v42, v42, v42
    v_and_b32 v42, s7, v42
    v_mul_f32 v66, v42, v82
    v_cvt_pk_bf16_f32 v67, v67, v67
    v_and_b32 v67, s7, v67
    v_cvt_pk_bf16_f32 v83, v83, v83
    v_and_b32 v83, s7, v83
    v_mul_f32 v42, v67, v67
    v_fma_f32 v42, v42, s46, v45
    v_mul_f32 v42, v42, v67
    v_exp_f32 v42, v42
    s_nop 0
    v_add_f32 v42, 1.0, v42
    v_rcp_f32 v42, v42
    s_nop 0
    v_mul_f32 v42, v42, v67
    v_cvt_pk_bf16_f32 v42, v42, v42
    v_and_b32 v42, s7, v42
    v_mul_f32 v67, v42, v83
    v_cvt_pk_bf16_f32 v64, v64, v65
    v_cvt_pk_bf16_f32 v65, v66, v67
    ds_write_b64 v9, v[64:65] offset:4608
    v_cvt_pk_bf16_f32 v68, v68, v68
    v_and_b32 v68, s7, v68
    v_cvt_pk_bf16_f32 v84, v84, v84
    v_and_b32 v84, s7, v84
    v_mul_f32 v42, v68, v68
    v_fma_f32 v42, v42, s46, v45
    v_mul_f32 v42, v42, v68
    v_exp_f32 v42, v42
    s_nop 0
    v_add_f32 v42, 1.0, v42
    v_rcp_f32 v42, v42
    s_nop 0
    v_mul_f32 v42, v42, v68
    v_cvt_pk_bf16_f32 v42, v42, v42
    v_and_b32 v42, s7, v42
    v_mul_f32 v68, v42, v84
    v_cvt_pk_bf16_f32 v69, v69, v69
    v_and_b32 v69, s7, v69
    v_cvt_pk_bf16_f32 v85, v85, v85
    v_and_b32 v85, s7, v85
    v_mul_f32 v42, v69, v69
    v_fma_f32 v42, v42, s46, v45
    v_mul_f32 v42, v42, v69
    v_exp_f32 v42, v42
    s_nop 0
    v_add_f32 v42, 1.0, v42
    v_rcp_f32 v42, v42
    s_nop 0
    v_mul_f32 v42, v42, v69
    v_cvt_pk_bf16_f32 v42, v42, v42
    v_and_b32 v42, s7, v42
    v_mul_f32 v69, v42, v85
    v_cvt_pk_bf16_f32 v70, v70, v70
    v_and_b32 v70, s7, v70
    v_cvt_pk_bf16_f32 v86, v86, v86
    v_and_b32 v86, s7, v86
    v_mul_f32 v42, v70, v70
    v_fma_f32 v42, v42, s46, v45
    v_mul_f32 v42, v42, v70
    v_exp_f32 v42, v42
    s_nop 0
    v_add_f32 v42, 1.0, v42
    v_rcp_f32 v42, v42
    s_nop 0
    v_mul_f32 v42, v42, v70
    v_cvt_pk_bf16_f32 v42, v42, v42
    v_and_b32 v42, s7, v42
    v_mul_f32 v70, v42, v86
    v_cvt_pk_bf16_f32 v71, v71, v71
    v_and_b32 v71, s7, v71
    v_cvt_pk_bf16_f32 v87, v87, v87
    v_and_b32 v87, s7, v87
    v_mul_f32 v42, v71, v71
    v_fma_f32 v42, v42, s46, v45
    v_mul_f32 v42, v42, v71
    v_exp_f32 v42, v42
    s_nop 0
    v_add_f32 v42, 1.0, v42
    v_rcp_f32 v42, v42
    s_nop 0
    v_mul_f32 v42, v42, v71
    v_cvt_pk_bf16_f32 v42, v42, v42
    v_and_b32 v42, s7, v42
    v_mul_f32 v71, v42, v87
    v_cvt_pk_bf16_f32 v68, v68, v69
    v_cvt_pk_bf16_f32 v69, v70, v71
    ds_write_b64 v9, v[68:69] offset:4640
    v_cvt_pk_bf16_f32 v72, v72, v72
    v_and_b32 v72, s7, v72
    v_cvt_pk_bf16_f32 v88, v88, v88
    v_and_b32 v88, s7, v88
    v_mul_f32 v42, v72, v72
    v_fma_f32 v42, v42, s46, v45
    v_mul_f32 v42, v42, v72
    v_exp_f32 v42, v42
    s_nop 0
    v_add_f32 v42, 1.0, v42
    v_rcp_f32 v42, v42
    s_nop 0
    v_mul_f32 v42, v42, v72
    v_cvt_pk_bf16_f32 v42, v42, v42
    v_and_b32 v42, s7, v42
    v_mul_f32 v72, v42, v88
    v_cvt_pk_bf16_f32 v73, v73, v73
    v_and_b32 v73, s7, v73
    v_cvt_pk_bf16_f32 v89, v89, v89
    v_and_b32 v89, s7, v89
    v_mul_f32 v42, v73, v73
    v_fma_f32 v42, v42, s46, v45
    v_mul_f32 v42, v42, v73
    v_exp_f32 v42, v42
    s_nop 0
    v_add_f32 v42, 1.0, v42
    v_rcp_f32 v42, v42
    s_nop 0
    v_mul_f32 v42, v42, v73
    v_cvt_pk_bf16_f32 v42, v42, v42
    v_and_b32 v42, s7, v42
    v_mul_f32 v73, v42, v89
    v_cvt_pk_bf16_f32 v74, v74, v74
    v_and_b32 v74, s7, v74
    v_cvt_pk_bf16_f32 v90, v90, v90
    v_and_b32 v90, s7, v90
    v_mul_f32 v42, v74, v74
    v_fma_f32 v42, v42, s46, v45
    v_mul_f32 v42, v42, v74
    v_exp_f32 v42, v42
    s_nop 0
    v_add_f32 v42, 1.0, v42
    v_rcp_f32 v42, v42
    s_nop 0
    v_mul_f32 v42, v42, v74
    v_cvt_pk_bf16_f32 v42, v42, v42
    v_and_b32 v42, s7, v42
    v_mul_f32 v74, v42, v90
    v_cvt_pk_bf16_f32 v75, v75, v75
    v_and_b32 v75, s7, v75
    v_cvt_pk_bf16_f32 v91, v91, v91
    v_and_b32 v91, s7, v91
    v_mul_f32 v42, v75, v75
    v_fma_f32 v42, v42, s46, v45
    v_mul_f32 v42, v42, v75
    v_exp_f32 v42, v42
    s_nop 0
    v_add_f32 v42, 1.0, v42
    v_rcp_f32 v42, v42
    s_nop 0
    v_mul_f32 v42, v42, v75
    v_cvt_pk_bf16_f32 v42, v42, v42
    v_and_b32 v42, s7, v42
    v_mul_f32 v75, v42, v91
    v_cvt_pk_bf16_f32 v72, v72, v73
    v_cvt_pk_bf16_f32 v73, v74, v75
    ds_write_b64 v9, v[72:73] offset:4672
    v_cvt_pk_bf16_f32 v76, v76, v76
    v_and_b32 v76, s7, v76
    v_cvt_pk_bf16_f32 v92, v92, v92
    v_and_b32 v92, s7, v92
    v_mul_f32 v42, v76, v76
    v_fma_f32 v42, v42, s46, v45
    v_mul_f32 v42, v42, v76
    v_exp_f32 v42, v42
    s_nop 0
    v_add_f32 v42, 1.0, v42
    v_rcp_f32 v42, v42
    s_nop 0
    v_mul_f32 v42, v42, v76
    v_cvt_pk_bf16_f32 v42, v42, v42
    v_and_b32 v42, s7, v42
    v_mul_f32 v76, v42, v92
    v_cvt_pk_bf16_f32 v77, v77, v77
    v_and_b32 v77, s7, v77
    v_cvt_pk_bf16_f32 v93, v93, v93
    v_and_b32 v93, s7, v93
    v_mul_f32 v42, v77, v77
    v_fma_f32 v42, v42, s46, v45
    v_mul_f32 v42, v42, v77
    v_exp_f32 v42, v42
    s_nop 0
    v_add_f32 v42, 1.0, v42
    v_rcp_f32 v42, v42
    s_nop 0
    v_mul_f32 v42, v42, v77
    v_cvt_pk_bf16_f32 v42, v42, v42
    v_and_b32 v42, s7, v42
    v_mul_f32 v77, v42, v93
    v_cvt_pk_bf16_f32 v78, v78, v78
    v_and_b32 v78, s7, v78
    v_cvt_pk_bf16_f32 v94, v94, v94
    v_and_b32 v94, s7, v94
    v_mul_f32 v42, v78, v78
    v_fma_f32 v42, v42, s46, v45
    v_mul_f32 v42, v42, v78
    v_exp_f32 v42, v42
    s_nop 0
    v_add_f32 v42, 1.0, v42
    v_rcp_f32 v42, v42
    s_nop 0
    v_mul_f32 v42, v42, v78
    v_cvt_pk_bf16_f32 v42, v42, v42
    v_and_b32 v42, s7, v42
    v_mul_f32 v78, v42, v94
    v_cvt_pk_bf16_f32 v79, v79, v79
    v_and_b32 v79, s7, v79
    v_cvt_pk_bf16_f32 v95, v95, v95
    v_and_b32 v95, s7, v95
    v_mul_f32 v42, v79, v79
    v_fma_f32 v42, v42, s46, v45
    v_mul_f32 v42, v42, v79
    v_exp_f32 v42, v42
    s_nop 0
    v_add_f32 v42, 1.0, v42
    v_rcp_f32 v42, v42
    s_nop 0
    v_mul_f32 v42, v42, v79
    v_cvt_pk_bf16_f32 v42, v42, v42
    v_and_b32 v42, s7, v42
    v_mul_f32 v79, v42, v95
    v_cvt_pk_bf16_f32 v76, v76, v77
    v_cvt_pk_bf16_f32 v77, v78, v79
    ds_write_b64 v9, v[76:77] offset:4704
    s_waitcnt vmcnt(0) lgkmcnt(0)
    ds_read_b128 v[16:19], v8 offset:4608
    ds_read_b128 v[20:23], v8 offset:4672
    ds_read_b64_tr_b16 v[96:97], v15 offset:0
    ds_read_b64_tr_b16 v[98:99], v15 offset:1024
    ds_read_b64_tr_b16 v[100:101], v15 offset:8192
    ds_read_b64_tr_b16 v[102:103], v15 offset:9216
    ds_read_b64_tr_b16 v[104:105], v15 offset:32
    ds_read_b64_tr_b16 v[106:107], v15 offset:1056
    ds_read_b64_tr_b16 v[108:109], v15 offset:8224
    ds_read_b64_tr_b16 v[110:111], v15 offset:9248
    s_waitcnt lgkmcnt(0)
    ds_read_b64_tr_b16 v[112:113], v15 offset:64
    ds_read_b64_tr_b16 v[114:115], v15 offset:1088
    ds_read_b64_tr_b16 v[116:117], v15 offset:8256
    ds_read_b64_tr_b16 v[118:119], v15 offset:9280
    ds_read_b64_tr_b16 v[120:121], v15 offset:96
    ds_read_b64_tr_b16 v[122:123], v15 offset:1120
    ds_read_b64_tr_b16 v[124:125], v15 offset:8288
    ds_read_b64_tr_b16 v[126:127], v15 offset:9312
    s_waitcnt lgkmcnt(0)
    v_mfma_f32_16x16x32_bf16 v[64:67], v[96:99], v[16:19], 0
    v_mfma_f32_16x16x32_bf16 v[64:67], v[100:103], v[20:23], v[64:67]
    v_mfma_f32_16x16x32_bf16 v[68:71], v[104:107], v[16:19], 0
    v_mfma_f32_16x16x32_bf16 v[68:71], v[108:111], v[20:23], v[68:71]
    v_mfma_f32_16x16x32_bf16 v[72:75], v[112:115], v[16:19], 0
    v_mfma_f32_16x16x32_bf16 v[72:75], v[116:119], v[20:23], v[72:75]
    v_mfma_f32_16x16x32_bf16 v[76:79], v[120:123], v[16:19], 0
    v_mfma_f32_16x16x32_bf16 v[76:79], v[124:127], v[20:23], v[76:79]
    s_nop 7
    ds_read_b64_tr_b16 v[96:97], v15 offset:128
    ds_read_b64_tr_b16 v[98:99], v15 offset:1152
    ds_read_b64_tr_b16 v[100:101], v15 offset:8320
    ds_read_b64_tr_b16 v[102:103], v15 offset:9344
    ds_read_b64_tr_b16 v[104:105], v15 offset:160
    ds_read_b64_tr_b16 v[106:107], v15 offset:1184
    ds_read_b64_tr_b16 v[108:109], v15 offset:8352
    ds_read_b64_tr_b16 v[110:111], v15 offset:9376
    s_waitcnt lgkmcnt(0)
    ds_read_b64_tr_b16 v[112:113], v15 offset:192
    ds_read_b64_tr_b16 v[114:115], v15 offset:1216
    ds_read_b64_tr_b16 v[116:117], v15 offset:8384
    ds_read_b64_tr_b16 v[118:119], v15 offset:9408
    ds_read_b64_tr_b16 v[120:121], v15 offset:224
    ds_read_b64_tr_b16 v[122:123], v15 offset:1248
    ds_read_b64_tr_b16 v[124:125], v15 offset:8416
    ds_read_b64_tr_b16 v[126:127], v15 offset:9440
    s_waitcnt lgkmcnt(0)
    v_mfma_f32_16x16x32_bf16 v[80:83], v[96:99], v[16:19], 0
    v_mfma_f32_16x16x32_bf16 v[80:83], v[100:103], v[20:23], v[80:83]
    v_mfma_f32_16x16x32_bf16 v[84:87], v[104:107], v[16:19], 0
    v_mfma_f32_16x16x32_bf16 v[84:87], v[108:111], v[20:23], v[84:87]
    v_mfma_f32_16x16x32_bf16 v[88:91], v[112:115], v[16:19], 0
    v_mfma_f32_16x16x32_bf16 v[88:91], v[116:119], v[20:23], v[88:91]
    v_mfma_f32_16x16x32_bf16 v[92:95], v[120:123], v[16:19], 0
    v_mfma_f32_16x16x32_bf16 v[92:95], v[124:127], v[20:23], v[92:95]
    s_nop 7
    s_lshl_b32 s43, s95, 14
    s_lshl_b32 s46, s45, 12
    s_add_u32 s43, s43, s46
    s_add_u32 s43, s43, 1048576
    v_and_b32 v6, 7, v4
    v_lshlrev_b32 v6, 7, v6
    v_lshl_add_u32 v6, v5, 4, v6
    v_add_u32 v6, s43, v6
    v_lshrrev_b32 v7, 3, v4
    v_lshl_add_u32 v6, v7, 6, v6
    v_and_b32 v7, 1, v5
    v_cmp_eq_u32 vcc, 1, v7
    v_mov_b32 v44, s90
    v_mov_b32 v45, s91
    v_cndmask_b32 v44, v44, v45, vcc
    v_lshrrev_b32 v45, 8, v44
    v_lshrrev_b32 v46, 16, v44
    v_lshrrev_b32 v47, 24, v44
    s_movk_i32 s43, 0xff
    v_cmp_lt_u32 vcc, 7, v4
    s_nop 1
    v_cndmask_b32 v64, v64, v68, vcc
    v_bfi_b32 v64, s43, v44, v64
    v_cndmask_b32 v65, v65, v69, vcc
    v_bfi_b32 v65, s43, v45, v65
    v_cndmask_b32 v66, v66, v70, vcc
    v_bfi_b32 v66, s43, v46, v66
    v_cndmask_b32 v67, v67, v71, vcc
    v_bfi_b32 v67, s43, v47, v67
    v_cndmask_b32 v72, v72, v76, vcc
    v_bfi_b32 v72, s43, v44, v72
    v_cndmask_b32 v73, v73, v77, vcc
    v_bfi_b32 v73, s43, v45, v73
    v_cndmask_b32 v74, v74, v78, vcc
    v_bfi_b32 v74, s43, v46, v74
    v_cndmask_b32 v75, v75, v79, vcc
    v_bfi_b32 v75, s43, v47, v75
    v_cndmask_b32 v80, v80, v84, vcc
    v_bfi_b32 v80, s43, v44, v80
    v_cndmask_b32 v81, v81, v85, vcc
    v_bfi_b32 v81, s43, v45, v81
    v_cndmask_b32 v82, v82, v86, vcc
    v_bfi_b32 v82, s43, v46, v82
    v_cndmask_b32 v83, v83, v87, vcc
    v_bfi_b32 v83, s43, v47, v83
    v_cndmask_b32 v88, v88, v92, vcc
    v_bfi_b32 v88, s43, v44, v88
    v_cndmask_b32 v89, v89, v93, vcc
    v_bfi_b32 v89, s43, v45, v89
    v_cndmask_b32 v90, v90, v94, vcc
    v_bfi_b32 v90, s43, v46, v90
    v_cndmask_b32 v91, v91, v95, vcc
    v_bfi_b32 v91, s43, v47, v91
    buffer_store_dwordx4 v[64:67], v6, s[96:99], 0 offen offset:0 sc1 nt
    buffer_store_dwordx4 v[72:75], v6, s[96:99], 0 offen offset:1024 sc1 nt
    buffer_store_dwordx4 v[80:83], v6, s[96:99], 0 offen offset:2048 sc1 nt
    buffer_store_dwordx4 v[88:91], v6, s[96:99], 0 offen offset:3072 sc1 nt
L_noffn:
    s_cmp_eq_u32 s45, 3
    s_cbranch_scc1 L_nog
    s_cmp_eq_u32 s45, 2
    s_cbranch_scc0 L_late
    s_xor_b32 s60, s2, 97
    s_and_b32 s60, s60, 0xe7
    s_lshl_b32 s60, s60, 7
    s_xor_b32 s61, s2, 194
    s_and_b32 s61, s61, 0xe7
    s_lshl_b32 s61, s61, 7
    s_xor_b32 s62, s2, 35
    s_and_b32 s62, s62, 0xe7
    s_lshl_b32 s62, s62, 7
    s_xor_b32 s63, s2, 132
    s_and_b32 s63, s63, 0xe7
    s_lshl_b32 s63, s63, 7
    s_xor_b32 s64, s2, 229
    s_and_b32 s64, s64, 0xe7
    s_lshl_b32 s64, s64, 7
    s_xor_b32 s65, s2, 70
    s_and_b32 s65, s65, 0xe7
    s_lshl_b32 s65, s65, 7
    s_xor_b32 s66, s2, 167
    s_and_b32 s66, s66, 0xe7
    s_lshl_b32 s66, s66, 7
    s_xor_b32 s67, s2, 128
    s_and_b32 s67, s67, 0xe7
    s_lshl_b32 s67, s67, 7
    s_lshl_b32 s43, s2, 7
    s_add_u32 s43, s43, 65536
    v_lshl_add_u32 v42, v0, 4, s43
    v_mov_b32 v45, s52
    v_mov_b32 v47, s52
    s_mov_b32 s54, 64
    s_mov_b32 s44, 262144
    s_mov_b64 exec, 255
L_pace:
    ds_read_b32 v44, v39 offset:2496
    s_waitcnt lgkmcnt(0)
    v_readfirstlane_b32 s46, v44
    s_nop 0
    s_cmp_ge_u32 s46, 216
    s_cbranch_scc1 L_pace_end
    s_cmp_ge_u32 s46, s54
    s_cbranch_scc1 L_pace_go
    s_sleep 4
    s_sub_u32 s44, s44, 1
    s_cmp_lg_u32 s44, 0
    s_cbranch_scc1 L_pace
    s_branch L_pace_end
L_pace_go:
    s_cmp_lt_u32 s46, 0
    s_cselect_b32 s68, 15, 15
    s_or_b32 s54, s46, s68
    s_add_u32 s54, s54, 1
    s_cmp_lt_u32 s46, 16
    s_cselect_b32 s68, 8, 8
    s_and_b32 s43, s2, 24
    s_cbranch_scc1 L_nopub
    v_mov_b32 v46, v44
    buffer_store_dwordx4 v[44:47], v42, s[96:99], 0 offen sc1
L_nopub:
    s_load_dwordx2 s[8:9], s[38:39], s60 offset:65536 glc
    s_load_dwordx2 s[10:11], s[38:39], s61 offset:65536 glc
    s_load_dwordx2 s[12:13], s[38:39], s62 offset:65536 glc
    s_load_dwordx2 s[14:15], s[38:39], s63 offset:65536 glc
    s_load_dwordx2 s[16:17], s[38:39], s64 offset:65536 glc
    s_load_dwordx2 s[18:19], s[38:39], s65 offset:65536 glc
    s_load_dwordx2 s[20:21], s[38:39], s66 offset:65536 glc
    s_load_dwordx2 s[22:23], s[38:39], s67 offset:65536 glc
    s_sub_i32 s46, s46, s68
    s_mov_b32 s55, 0
    s_mov_b32 s56, 0
    s_waitcnt lgkmcnt(0)
    s_sub_i32 s57, s8, s46
    s_cmp_eq_u32 s9, s52
    s_cselect_b32 s57, s57, 0
    s_addc_u32 s56, s56, 0
    s_add_i32 s55, s55, s57
    s_sub_i32 s57, s10, s46
    s_cmp_eq_u32 s11, s52
    s_cselect_b32 s57, s57, 0
    s_addc_u32 s56, s56, 0
    s_add_i32 s55, s55, s57
    s_sub_i32 s57, s12, s46
    s_cmp_eq_u32 s13, s52
    s_cselect_b32 s57, s57, 0
    s_addc_u32 s56, s56, 0
    s_add_i32 s55, s55, s57
    s_sub_i32 s57, s14, s46
    s_cmp_eq_u32 s15, s52
    s_cselect_b32 s57, s57, 0
    s_addc_u32 s56, s56, 0
    s_add_i32 s55, s55, s57
    s_sub_i32 s57, s16, s46
    s_cmp_eq_u32 s17, s52
    s_cselect_b32 s57, s57, 0
    s_addc_u32 s56, s56, 0
    s_add_i32 s55, s55, s57
    s_sub_i32 s57, s18, s46
    s_cmp_eq_u32 s19, s52
    s_cselect_b32 s57, s57, 0
    s_addc_u32 s56, s56, 0
    s_add_i32 s55, s55, s57
    s_sub_i32 s57, s20, s46
    s_cmp_eq_u32 s21, s52
    s_cselect_b32 s57, s57, 0
    s_addc_u32 s56, s56, 0
    s_add_i32 s55, s55, s57
    s_sub_i32 s57, s22, s46
    s_cmp_eq_u32 s23, s52
    s_cselect_b32 s57, s57, 0
    s_addc_u32 s56, s56, 0
    s_add_i32 s55, s55, s57
    s_cmp_eq_u32 s56, 0
    s_cbranch_scc1 L_pace
    s_mov_b32 s57, 1
    s_mul_i32 s59, s56, -7
    s_lshl_b32 s43, s55, 1
    s_cmp_gt_i32 s43, s59
    s_cselect_b32 s57, 2, s57
    s_mul_i32 s59, s56, 7
    s_lshl_b32 s43, s55, 1
    s_cmp_gt_i32 s43, s59
    s_cselect_b32 s57, 4, s57
    s_mul_i32 s59, s56, 20
    s_lshl_b32 s43, s55, 1
    s_cmp_gt_i32 s43, s59
    s_cselect_b32 s57, 6, s57
    v_mov_b32 v48, s57
    ds_write_b32 v39, v48 offset:2500
    s_branch L_pace
L_pace_end:
    s_mov_b64 exec, -1
    s_branch L_nog
L_late:
    s_mov_b32 s44, 262144
L_pg:
    ds_read_b32 v41, v39 offset:2496
    s_waitcnt lgkmcnt(0)
    v_readfirstlane_b32 s46, v41
    s_nop 0
    s_cmp_ge_u32 s46, 200
    s_cbranch_scc1 L_pg_ok
    s_sleep 32
    s_sub_u32 s44, s44, 1
    s_cmp_lg_u32 s44, 0
    s_cbranch_scc1 L_pg
L_pg_ok:
    s_cmp_lg_u32 s45, 1
    s_cbranch_scc1 L_noepoch
    s_cmp_lg_u32 s2, 1
    s_cbranch_scc1 L_nog
    v_lshlrev_b32 v40, 10, v0
    v_add_u32 v40, 262144, v40
    s_mov_b32 s44, 262144
    s_mov_b32 s56, 0
L_pollE:
    buffer_load_dwordx4 v[64:67], v40, s[96:99], s56 offen sc1
    buffer_load_dwordx4 v[68:71], v40, s[96:99], s56 offen offset:16 sc1
    s_waitcnt vmcnt(0)
    v_and_b32 v44, 15, v64
    v_and_b32 v45, 15, v65
    v_lshl_or_b32 v44, v45, 4, v44
    v_and_b32 v45, 15, v66
    v_lshl_or_b32 v44, v45, 8, v44
    v_and_b32 v45, 15, v67
    v_lshl_or_b32 v44, v45, 12, v44
    v_and_b32 v45, 15, v68
    v_lshl_or_b32 v44, v45, 16, v44
    v_and_b32 v45, 15, v69
    v_lshl_or_b32 v44, v45, 20, v44
    v_and_b32 v45, 15, v70
    v_lshl_or_b32 v44, v45, 24, v44
    v_and_b32 v45, 15, v71
    v_lshl_or_b32 v44, v45, 28, v44
    v_cmp_ne_u32 vcc, s90, v44
    s_cbranch_vccz L_pollE_ok
    s_sleep 100
    s_sub_u32 s44, s44, 1
    s_cmp_lg_u32 s44, 0
    s_cbranch_scc1 L_pollE
L_pollE_ok:
    s_add_u32 s56, s56, 0x10000
    s_cmp_lt_u32 s56, 0x40000
    s_cbranch_scc1 L_pollE
    v_mov_b32 v40, 0
    s_mov_b64 exec, 1
    buffer_store_dwordx2 v[24:25], v40, s[96:99], 0 offen sc1
    s_mov_b64 exec, -1
    s_branch L_nog
L_noepoch:
    s_lshr_b32 s43, s94, 1
    s_lshl_b32 s43, s43, 10
    s_lshl_b32 s46, s4, 7
    s_add_u32 s43, s43, s46
    s_and_b32 s46, s94, 1
    s_lshl_b32 s46, s46, 6
    s_add_u32 s43, s43, s46
    s_add_u32 s43, s43, 1048576
    v_lshrrev_b32 v40, 2, v0
    v_lshlrev_b32 v40, 14, v40
    v_and_b32 v41, 3, v0
    v_lshl_add_u32 v40, v41, 4, v40
    v_add_u32 v40, s43, v40
    v_and_b32 v41, 1, v0
    v_cmp_eq_u32 vcc, 1, v41
    v_mov_b32 v56, s90
    v_mov_b32 v57, s91
    v_cndmask_b32 v56, v56, v57, vcc
    v_bfe_u32 v68, v56, 0, 8
    v_bfe_u32 v69, v56, 8, 8
    v_bfe_u32 v70, v56, 16, 8
    v_bfe_u32 v71, v56, 24, 8
    s_mov_b32 s56, 0x40000
    s_mov_b32 s57, 0x0c0c0400
    s_mov_b32 s59, 0xffffff00
    s_mov_b32 s44, 262144
L_pollG:
    buffer_load_dwordx4 v[64:67], v40, s[96:99], 0 offen sc1 nt
    s_mov_b32 exec_hi, 0xffff
    buffer_load_dwordx4 v[68:71], v40, s[96:99], s56 offen sc1 nt
    s_mov_b64 exec, -1
    s_waitcnt vmcnt(0)
    v_perm_b32 v44, v65, v64, s57
    v_perm_b32 v45, v67, v66, s57
    v_lshl_or_b32 v44, v45, 16, v44
    v_xor_b32 v44, v44, v56
    v_perm_b32 v46, v69, v68, s57
    v_perm_b32 v47, v71, v70, s57
    v_lshl_or_b32 v46, v47, 16, v46
    v_xor_b32 v46, v46, v56
    v_or_b32 v44, v44, v46
    v_cmp_ne_u32 vcc, 0, v44
    s_sub_u32 s44, s44, 1
    s_cbranch_vccz L_pollG_ok
    s_sleep 100
    s_cmp_lg_u32 s44, 0
    s_cbranch_scc1 L_pollG
L_pollG_ok:
    v_and_b32 v64, s59, v64
    v_and_b32 v65, s59, v65
    v_and_b32 v66, s59, v66
    v_and_b32 v67, s59, v67
    v_and_b32 v68, s59, v68
    v_and_b32 v69, s59, v69
    v_and_b32 v70, s59, v70
    v_and_b32 v71, s59, v71
    v_add_f32 v48, v64, v68
    v_add_f32 v49, v65, v69
    v_add_f32 v50, v66, v70
    v_add_f32 v51, v67, v71
    v_add_f32_dpp v48, v48, v48 row_ror:4 row_mask:0xf bank_mask:0xf
    v_add_f32_dpp v49, v49, v49 row_ror:4 row_mask:0xf bank_mask:0xf
    v_add_f32_dpp v50, v50, v50 row_ror:4 row_mask:0xf bank_mask:0xf
    v_add_f32_dpp v51, v51, v51 row_ror:4 row_mask:0xf bank_mask:0xf
    v_add_f32_dpp v48, v48, v48 row_ror:8 row_mask:0xf bank_mask:0xf
    v_add_f32_dpp v49, v49, v49 row_ror:8 row_mask:0xf bank_mask:0xf
    v_add_f32_dpp v50, v50, v50 row_ror:8 row_mask:0xf bank_mask:0xf
    v_add_f32_dpp v51, v51, v51 row_ror:8 row_mask:0xf bank_mask:0xf
    v_mov_b32 v44, v48
    s_nop 1
    v_permlane16_swap_b32 v48, v44
    v_add_f32 v48, v48, v44
    v_mov_b32 v45, v49
    s_nop 1
    v_permlane16_swap_b32 v49, v45
    v_add_f32 v49, v49, v45
    v_mov_b32 v46, v50
    s_nop 1
    v_permlane16_swap_b32 v50, v46
    v_add_f32 v50, v50, v46
    v_mov_b32 v47, v51
    s_nop 1
    v_permlane16_swap_b32 v51, v47
    v_add_f32 v51, v51, v47
    v_mov_b32 v44, v48
    s_nop 1
    v_permlane32_swap_b32 v48, v44
    v_add_f32 v48, v48, v44
    v_mov_b32 v45, v49
    s_nop 1
    v_permlane32_swap_b32 v49, v45
    v_add_f32 v49, v49, v45
    v_mov_b32 v46, v50
    s_nop 1
    v_permlane32_swap_b32 v50, v46
    v_add_f32 v50, v50, v46
    v_mov_b32 v47, v51
    s_nop 1
    v_permlane32_swap_b32 v51, v47
    v_add_f32 v51, v51, v47
    v_cvt_pk_bf16_f32 v48, v48, v48
    v_and_b32 v48, s7, v48
    v_mul_f32 v42, s6, v48
    v_exp_f32 v42, -v42
    s_nop 0
    v_add_f32 v42, 1.0, v42
    v_rcp_f32 v42, v42
    s_nop 0
    v_mul_f32 v48, v42, v48
    v_cvt_pk_bf16_f32 v48, v48, v48
    v_and_b32 v48, s7, v48
    v_cvt_pk_bf16_f32 v49, v49, v49
    v_and_b32 v49, s7, v49
    v_mul_f32 v42, s6, v49
    v_exp_f32 v42, -v42
    s_nop 0
    v_add_f32 v42, 1.0, v42
    v_rcp_f32 v42, v42
    s_nop 0
    v_mul_f32 v49, v42, v49
    v_cvt_pk_bf16_f32 v49, v49, v49
    v_and_b32 v49, s7, v49
    v_cvt_pk_bf16_f32 v50, v50, v50
    v_and_b32 v50, s7, v50
    v_mul_f32 v42, s6, v50
    v_exp_f32 v42, -v42
    s_nop 0
    v_add_f32 v42, 1.0, v42
    v_rcp_f32 v42, v42
    s_nop 0
    v_mul_f32 v50, v42, v50
    v_cvt_pk_bf16_f32 v50, v50, v50
    v_and_b32 v50, s7, v50
    v_cvt_pk_bf16_f32 v51, v51, v51
    v_and_b32 v51, s7, v51
    v_mul_f32 v42, s6, v51
    v_exp_f32 v42, -v42
    s_nop 0
    v_add_f32 v42, 1.0, v42
    v_rcp_f32 v42, v42
    s_nop 0
    v_mul_f32 v51, v42, v51
    v_cvt_pk_bf16_f32 v51, v51, v51
    v_and_b32 v51, s7, v51
    v_lshlrev_b32 v8, 4, v0
    s_mov_b64 exec, 15
    ds_write_b128 v8, v[48:51] offset:2368
    s_mov_b64 exec, -1
L_nog:
    s_lshl_b32 s43, s2, 11
    s_lshl_b32 s46, s45, 9
    s_add_u32 s43, s43, s46
    s_add_u32 s43, s43, 3145728
    v_lshl_add_u32 v12, v0, 3, s43
    v_and_b32 v6, 2, v0
    v_cmp_eq_u32 vcc, 2, v6
    v_mov_b32 v62, s90
    v_mov_b32 v63, s91
    v_cndmask_b32 v62, v62, v63, vcc
    v_and_b32 v6, 1, v0
    v_lshlrev_b32 v6, 4, v6
    v_lshrrev_b32 v62, v6, v62
    v_lshrrev_b32 v63, 8, v62
    s_movk_i32 s14, 0xff
    v_lshlrev_b32 v6, 3, v0
    s_lshl_b32 s43, s45, 8
    v_lshl_add_u32 v7, v0, 2, s43
    v_lshl_add_u32 v8, v5, 4, s43
    v_mov_b32 v9, 0
    v_cmp_eq_u32 s[8:9], 1, v5
    v_cmp_eq_u32 s[10:11], 2, v5
    v_cmp_eq_u32 s[12:13], 3, v5
    s_waitcnt vmcnt(0) lgkmcnt(0)
    s_setprio 3
    s_barrier
    ds_read_b64 v[24:25], v6 offset:256
    ds_read_b64 v[26:27], v6 offset:768
    ds_read_b64 v[28:29], v6 offset:1280
    ds_read_b64 v[30:31], v6 offset:1792
    s_waitcnt lgkmcnt(0)
    v_add_f32 v24, v24, v26
    v_add_f32 v25, v25, v27
    v_add_f32 v28, v28, v30
    v_add_f32 v29, v29, v31
    v_add_f32 v42, v24, v28
    v_add_f32 v43, v25, v29
    v_cvt_pk_bf16_f32 v42, v42, v43
    ds_write_b32 v7, v42 offset:2560
    s_waitcnt lgkmcnt(0)
    ds_read_b128 v[44:47], v8 offset:2560
    ds_read_b128 v[48:51], v8 offset:2624
    ds_read_b128 v[52:55], v8 offset:2688
    ds_read_b128 v[56:59], v8 offset:2752
    s_waitcnt lgkmcnt(3)
    v_mfma_f32_16x16x32_bf16 v[64:67], v[44:47], v[128:131], 0
    v_mfma_f32_16x16x32_bf16 v[68:71], v[44:47], v[132:135], 0
    v_mfma_f32_16x16x32_bf16 v[72:75], v[44:47], v[136:139], 0
    v_mfma_f32_16x16x32_bf16 v[76:79], v[44:47], v[140:143], 0
    v_mfma_f32_16x16x32_bf16 v[80:83], v[44:47], v[144:147], 0
    v_mfma_f32_16x16x32_bf16 v[84:87], v[44:47], v[148:151], 0
    v_mfma_f32_16x16x32_bf16 v[88:91], v[44:47], v[152:155], 0
    v_mfma_f32_16x16x32_bf16 v[92:95], v[44:47], v[156:159], 0
    s_waitcnt lgkmcnt(2)
    v_mfma_f32_16x16x32_bf16 v[64:67], v[48:51], v[160:163], v[64:67]
    v_mfma_f32_16x16x32_bf16 v[68:71], v[48:51], v[164:167], v[68:71]
    v_mfma_f32_16x16x32_bf16 v[72:75], v[48:51], v[168:171], v[72:75]
    v_mfma_f32_16x16x32_bf16 v[76:79], v[48:51], v[172:175], v[76:79]
    v_mfma_f32_16x16x32_bf16 v[80:83], v[48:51], v[176:179], v[80:83]
    v_mfma_f32_16x16x32_bf16 v[84:87], v[48:51], v[180:183], v[84:87]
    v_mfma_f32_16x16x32_bf16 v[88:91], v[48:51], v[184:187], v[88:91]
    v_mfma_f32_16x16x32_bf16 v[92:95], v[48:51], v[188:191], v[92:95]
    s_waitcnt lgkmcnt(1)
    v_mfma_f32_16x16x32_bf16 v[64:67], v[52:55], v[192:195], v[64:67]
    v_mfma_f32_16x16x32_bf16 v[68:71], v[52:55], v[196:199], v[68:71]
    v_mfma_f32_16x16x32_bf16 v[72:75], v[52:55], v[200:203], v[72:75]
    v_mfma_f32_16x16x32_bf16 v[76:79], v[52:55], v[204:207], v[76:79]
    v_mfma_f32_16x16x32_bf16 v[80:83], v[52:55], v[208:211], v[80:83]
    v_mfma_f32_16x16x32_bf16 v[84:87], v[52:55], v[212:215], v[84:87]
    v_mfma_f32_16x16x32_bf16 v[88:91], v[52:55], v[216:219], v[88:91]
    v_mfma_f32_16x16x32_bf16 v[92:95], v[52:55], v[220:223], v[92:95]
    s_waitcnt lgkmcnt(0)
    v_mfma_f32_16x16x32_bf16 v[64:67], v[56:59], v[224:227], v[64:67]
    v_mfma_f32_16x16x32_bf16 v[68:71], v[56:59], v[228:231], v[68:71]
    v_mfma_f32_16x16x32_bf16 v[72:75], v[56:59], v[232:235], v[72:75]
    v_mfma_f32_16x16x32_bf16 v[76:79], v[56:59], v[236:239], v[76:79]
    v_mfma_f32_16x16x32_bf16 v[80:83], v[56:59], v[240:243], v[80:83]
    v_mfma_f32_16x16x32_bf16 v[84:87], v[56:59], v[244:247], v[84:87]
    v_mfma_f32_16x16x32_bf16 v[88:91], v[56:59], v[248:251], v[88:91]
    v_mfma_f32_16x16x32_bf16 v[92:95], v[56:59], v[252:255], v[92:95]
    s_nop 2
    v_cndmask_b32 v60, v64, v72, s[8:9]
    v_cndmask_b32 v61, v68, v76, s[8:9]
    v_cndmask_b32 v60, v60, v80, s[10:11]
    v_cndmask_b32 v61, v61, v84, s[10:11]
    v_cndmask_b32 v60, v60, v88, s[12:13]
    v_cndmask_b32 v61, v61, v92, s[12:13]
    v_bfi_b32 v60, s14, v62, v60
    v_bfi_b32 v61, s14, v63, v61
    buffer_store_dwordx2 v[60:61], v12, s[96:99], 0 offen sc1
L_fin:
L_end:
    s_endpgm
.section .rodata,"a"
.p2align 6
.amdhsa_kernel recurrent_scan__mha_block_cached__geglu_ffn__decode_kernel
.amdhsa_next_free_vgpr 256
.amdhsa_next_free_sgpr 102
.amdhsa_accum_offset 256
.amdhsa_group_segment_fixed_size 0
.amdhsa_kernarg_size 96
.amdhsa_user_sgpr_count 2
.amdhsa_user_sgpr_kernarg_segment_ptr 1
.amdhsa_system_sgpr_workgroup_id_x 1
.end_amdhsa_kernel
```
